```python
import torch

def _softmax(x, axis=-1):
    return torch.softmax(x, dim=axis)
def _gelu(x):
    return torch.nn.functional.gelu(x, approximate="tanh")
def _silu(x):
    return torch.nn.functional.silu(x)
def _sigmoid(x):
    return torch.sigmoid(x)
def _layernorm(x, axis=-1, eps=1e-5):
    m = x.mean(dim=axis, keepdim=True)
    v = x.var(dim=axis, keepdim=True, unbiased=False)
    return (x - m) / torch.sqrt(v + eps)
def _scatter_add(tgt, idx, src, axis=0):
    return tgt.clone().index_add_(axis, idx, src)
def _segment_sum(src, seg, n):
    out = torch.zeros((n,) + src.shape[1:], dtype=src.dtype)
    return out.index_add_(0, seg, src)
def _pad(x, pw):
    flat = tuple(v for pair in reversed(pw) for v in pair)
    return torch.nn.functional.pad(x, flat)

kernel_name = 'concat_heads__gqa_block_cached__gqa_block_cached__near_ridge'

def setup_inputs():

    _w = (lambda a: (lambda t: t.to(torch.bfloat16) if t.is_floating_point() else t)(torch.as_tensor(a)))
    def _A_setup():
        B, Sq, D = 8, 96, 576
        Hq, Hkv, Sk, Dh = 32, 16, 1024, 128
        assert Hq % Hkv == 0, (Hq, Hkv)
        return {
            "x": _w((lambda *s: torch.randn(*s, dtype=torch.bfloat16) * 0.8)(B, Sq, D)),
            "k_cache": _w((lambda *s: torch.randn(*s, dtype=torch.bfloat16) * 0.8)(B, Hkv, Sk, Dh)),
            "v_cache": _w((lambda *s: torch.randn(*s, dtype=torch.bfloat16) * 0.05)(B, Hkv, Sk, Dh)),
            "wq": _w((lambda *s: torch.randn(*s, dtype=torch.bfloat16) * 0.8)(D, Hq * Dh) * (D ** -0.5)),
            "wo": _w((lambda *s: torch.randn(*s, dtype=torch.bfloat16) * 0.05)(Hq * Dh, D) * ((Hq * Dh) ** -0.5)),
        }
    _A_in = _A_setup()

    def _B_setup():
        B, Sq, D = 8, 96, 576
        Hq, Hkv, Sk, Dh = 32, 16, 1024, 128
        assert Hq % Hkv == 0, (Hq, Hkv)
        return {
            "x": _w((lambda *s: torch.randn(*s, dtype=torch.bfloat16) * 0.8)(B, Sq, D)),
            "k_cache": _w((lambda *s: torch.randn(*s, dtype=torch.bfloat16) * 0.8)(B, Hkv, Sk, Dh)),
            "v_cache": _w((lambda *s: torch.randn(*s, dtype=torch.bfloat16) * 0.05)(B, Hkv, Sk, Dh)),
            "wq": _w((lambda *s: torch.randn(*s, dtype=torch.bfloat16) * 0.8)(D, Hq * Dh) * (D ** -0.5)),
            "wo": _w((lambda *s: torch.randn(*s, dtype=torch.bfloat16) * 0.05)(Hq * Dh, D) * ((Hq * Dh) ** -0.5)),
        }
    _B_in = _B_setup()

    return {
        "A_x": _A_in["x"],
        "A_k_cache": _A_in["k_cache"],
        "A_v_cache": _A_in["v_cache"],
        "A_wq": _A_in["wq"],
        "A_wo": _A_in["wo"],
        "B_x": _B_in["x"],
        "B_k_cache": _B_in["k_cache"],
        "B_v_cache": _B_in["v_cache"],
        "B_wq": _B_in["wq"],
        "B_wo": _B_in["wo"],
    }

def reference(A_x, A_k_cache, A_v_cache, A_wq, A_wo, B_x, B_k_cache, B_v_cache, B_wq, B_wo):
    def _A_ref(x, k_cache, v_cache, wq, wo):
        B, Sq, D = x.shape
        Hq, Dh = 32, 128
        Hkv = k_cache.shape[1]
        rep = Hq // Hkv
        q = (lambda x, *d: x.permute(*d))((x @ wq).reshape(B, Sq, Hq, Dh), 0, 2, 1, 3)
        k = (lambda x, n, axis: torch.repeat_interleave(x, n, dim=axis))(k_cache, rep, axis=1)
        v = (lambda x, n, axis: torch.repeat_interleave(x, n, dim=axis))(v_cache, rep, axis=1)
        scores = torch.einsum("bhqd,bhkd->bhqk", q, k) * (Dh ** -0.5)
        p = _softmax(scores, axis=-1)
        o = torch.einsum("bhqk,bhkd->bhqd", p, v)
        return (lambda x, *d: x.permute(*d))(o, 0, 2, 1, 3).reshape(B, Sq, Hq * Dh) @ wo

    def _B_ref(x, k_cache, v_cache, wq, wo):
        B, Sq, D = x.shape
        Hq, Dh = 32, 128
        Hkv = k_cache.shape[1]
        rep = Hq // Hkv
        q = (lambda x, *d: x.permute(*d))((x @ wq).reshape(B, Sq, Hq, Dh), 0, 2, 1, 3)
        k = (lambda x, n, axis: torch.repeat_interleave(x, n, dim=axis))(k_cache, rep, axis=1)
        v = (lambda x, n, axis: torch.repeat_interleave(x, n, dim=axis))(v_cache, rep, axis=1)
        scores = torch.einsum("bhqd,bhkd->bhqk", q, k) * (Dh ** -0.5)
        p = _softmax(scores, axis=-1)
        o = torch.einsum("bhqk,bhkd->bhqd", p, v)
        return (lambda x, *d: x.permute(*d))(o, 0, 2, 1, 3).reshape(B, Sq, Hq * Dh) @ wo

    a = _A_ref(A_x, A_k_cache, A_v_cache, A_wq, A_wo)
    b = _B_ref(B_x, B_k_cache, B_v_cache, B_wq, B_wo)
    return torch.concatenate([a, b], axis=-1)
```

```asm
; @launch grid=(256,1,1) block=(256,1,1) lds=163840
.amdgcn_target "amdgcn-amd-amdhsa--gfx950"
.text
.globl concat_heads__gqa_block_cached__gqa_block_cached__near_ridge_kernel
.p2align 8
.type concat_heads__gqa_block_cached__gqa_block_cached__near_ridge_kernel,@function
concat_heads__gqa_block_cached__gqa_block_cached__near_ridge_kernel:
    s_cmp_ge_u32 s2, 256
    s_cbranch_scc1 L_end
    s_load_dwordx16 s[64:79], s[0:1], 0
    s_load_dwordx8 s[80:87], s[0:1], 64
    s_load_dwordx2 s[88:89], s[0:1], 96
    v_lshrrev_b32 v2, 6, v0
    v_and_b32 v1, 63, v0
    s_bfe_u32 s43, s2, 0x10002
    v_readfirstlane_b32 s40, v2
    s_lshr_b32 s46, s2, 3
    s_and_b32 s3, s2, 3
    s_lshl_b32 s3, s3, 2
    s_and_b32 s45, s46, 3
    s_add_u32 s45, s45, s3
    s_lshr_b32 s44, s46, 2
    s_and_b32 s41, s40, 1
    s_lshr_b32 s42, s40, 1
    s_lshl_b32 s47, s40, 12
    s_mul_i32 s6, s44, 110592
    s_mov_b32 s10, 110592
    s_mov_b32 s11, 0x20000
    s_lshl_b32 s7, s45, 9
    s_sub_u32 s14, 4718592, s7
    s_mov_b32 s15, 0x20000
    s_and_b32 s4, s46, 3
    s_lshl_b32 s4, s4, 1
    s_add_u32 s3, s4, s44
    s_cmp_ge_u32 s3, 9
    s_cselect_b32 s5, 9, 0
    s_sub_u32 s3, s3, s5
    s_lshl_b32 s53, s3, 7
    s_lshl_b32 s100, s3, 19
    s_mul_i32 s59, s40, 3072
    v_lshrrev_b32 v2, 3, v1
    v_and_b32 v3, 7, v1
    v_lshrrev_b32 v5, 4, v1
    s_lshl_b32 s3, s41, 2
    v_xor_b32 v5, v5, v3
    v_xor_b32 v5, s3, v5
    v_lshlrev_b32 v5, 4, v5
    s_mul_i32 s3, s40, 24
    v_add_u32 v6, s3, v2
    v_mul_u32_u24 v6, 1152, v6
    v_add_u32 v122, v6, v5
    v_xor_b32 v5, 64, v5
    v_add_u32 v6, v6, v5
    v_add_u32 v123, 8192, v6
    v_add_u32 v124, 16384, v122
    v_bfe_u32 v4, v1, 4, 1
    v_lshlrev_b32 v4, 2, v4
    v_xor_b32 v4, v4, v3
    v_lshlrev_b32 v4, 4, v4
    v_lshl_add_u32 v4, v2, 13, v4
    s_lshl_b32 s3, s41, 8
    s_lshl_b32 s4, s42, 7
    s_add_u32 s3, s3, s4
    v_add_u32 v118, s3, v4
    v_add_u32 v119, 64512, v118
    v_add_u32 v120, 129024, v118
    v_add_u32 v121, 193536, v118
    s_waitcnt lgkmcnt(0)
    s_cmp_eq_u32 s43, 0
    s_cselect_b32 s8, s64, s74
    s_cselect_b32 s9, s65, s75
    s_cselect_b32 s12, s70, s80
    s_cselect_b32 s13, s71, s81
    s_add_u32 s8, s8, s6
    s_addc_u32 s9, s9, 0
    s_add_u32 s12, s12, s7
    s_addc_u32 s13, s13, 0
    s_add_u32 m0, s59, 81920
    s_nop 0
    buffer_load_dwordx4 v122, s[8:11], s53 offen offset:0 lds
    buffer_load_dwordx4 v123, s[8:11], s53 offen offset:1024 lds
    buffer_load_dwordx4 v124, s[8:11], s53 offen offset:2048 lds
    s_add_u32 m0, s47, 98304
    s_nop 0
    buffer_load_dwordx4 v118, s[12:15], s100 offen offset:0 lds
    buffer_load_dwordx4 v119, s[12:15], s100 offen offset:1024 lds
    buffer_load_dwordx4 v120, s[12:15], s100 offen offset:2048 lds
    buffer_load_dwordx4 v121, s[12:15], s100 offen offset:3072 lds
    s_add_u32 m0, s47, 114688
    s_add_u32 s100, s100, 262144
    s_cmp_eq_u32 s100, 4718592
    s_cselect_b32 s100, 0, s100
    buffer_load_dwordx4 v118, s[12:15], s100 offen offset:0 lds
    buffer_load_dwordx4 v119, s[12:15], s100 offen offset:1024 lds
    buffer_load_dwordx4 v120, s[12:15], s100 offen offset:2048 lds
    buffer_load_dwordx4 v121, s[12:15], s100 offen offset:3072 lds
    s_getpc_b64 s[4:5]
L_pc:
    s_and_b32 s3, s46, 7
    s_lshl_b32 s3, s3, 2
    s_add_u32 s3, s3, s40
    s_mul_i32 s3, s3, 1280
    v_min_u32 v2, 9, v1
    v_lshl_add_u32 v2, v2, 7, s3
    v_min_u32 v2, L_codeend-L_pc-4, v2
    global_load_dword v169, v2, s[4:5]
    s_cmp_eq_u32 s43, 0
    s_cselect_b32 s16, s66, s76
    s_cselect_b32 s17, s67, s77
    s_cselect_b32 s20, s68, s78
    s_cselect_b32 s21, s69, s79
    s_cselect_b32 s24, s72, s82
    s_cselect_b32 s25, s73, s83
    s_lshl_b32 s3, s44, 4
    s_add_u32 s3, s3, s45
    s_lshl_b32 s3, s3, 18
    s_add_u32 s16, s16, s3
    s_addc_u32 s17, s17, 0
    s_mov_b32 s18, 0x40000
    s_mov_b32 s19, 0x20000
    s_add_u32 s20, s20, s3
    s_addc_u32 s21, s21, 0
    s_mov_b32 s22, 0x40000
    s_mov_b32 s23, 0x20000
    v_and_b32 v2, 31, v1
    v_lshrrev_b32 v3, 5, v1
    v_bfe_u32 v4, v1, 1, 3
    v_xor_b32 v4, v4, v3
    v_lshlrev_b32 v4, 4, v4
    v_lshl_add_u32 v4, v2, 7, v4
    v_add_u32 v112, 32768, v4
    v_xor_b32 v113, 32, v112
    v_xor_b32 v114, 64, v112
    v_xor_b32 v115, 96, v112
    v_bfe_u32 v5, v1, 2, 2
    v_lshl_add_u32 v6, v3, 3, v5
    v_lshlrev_b32 v6, 7, v6
    v_bfe_u32 v7, v1, 3, 1
    v_lshl_add_u32 v6, v7, 6, v6
    v_bfe_u32 v7, v1, 4, 1
    v_lshl_add_u32 v6, v7, 5, v6
    v_and_b32 v7, 1, v1
    v_lshl_add_u32 v6, v7, 4, v6
    v_bfe_u32 v7, v1, 1, 1
    v_lshl_add_u32 v6, v7, 3, v6
    s_add_u32 s3, s47, 98304
    v_add_u32 v116, s3, v6
    v_xor_b32 v117, 64, v116
    v_and_b32 v2, 31, v1
    v_lshrrev_b32 v3, 5, v1
    v_and_b32 v4, 3, v2
    v_lshrrev_b32 v5, 3, v2
    v_lshl_add_u32 v4, v5, 2, v4
    v_xor_b32 v4, v4, v3
    s_lshl_b32 s3, s42, 3
    v_xor_b32 v4, s3, v4
    v_lshlrev_b32 v4, 4, v4
    v_lshl_add_u32 v4, v2, 8, v4
    s_lshl_b32 s3, s42, 13
    v_add_u32 v232, s3, v4
    v_xor_b32 v233, 32, v232
    v_xor_b32 v234, 64, v232
    v_xor_b32 v235, 96, v232
    v_xor_b32 v236, 128, v232
    v_xor_b32 v237, 160, v232
    v_xor_b32 v238, 192, v232
    v_xor_b32 v239, 224, v232
    v_bfe_u32 v5, v1, 2, 2
    v_lshl_add_u32 v6, v3, 2, v5
    v_lshlrev_b32 v6, 8, v6
    s_lshl_b32 s56, s42, 1
    v_xor_b32 v5, s56, v5
    v_lshl_add_u32 v6, v5, 6, v6
    v_bfe_u32 v7, v1, 4, 1
    v_lshl_add_u32 v6, v7, 5, v6
    v_and_b32 v7, 3, v1
    v_lshl_add_u32 v6, v7, 3, v6
    s_add_u32 s3, s3, 65536
    v_add_u32 v240, s3, v6
    v_xor_b32 v241, 64, v240
    v_xor_b32 v242, 128, v240
    v_xor_b32 v243, 192, v240
    v_lshrrev_b32 v2, 4, v1
    v_and_b32 v3, 15, v1
    s_lshl_b32 s3, s40, 2
    v_or_b32 v4, s3, v2
    v_xor_b32 v4, v4, v3
    v_lshlrev_b32 v4, 4, v4
    v_lshl_add_u32 v244, v2, 8, v4
    v_lshlrev_b32 v4, 2, v2
    v_xor_b32 v4, v4, v3
    v_lshlrev_b32 v4, 4, v4
    v_lshl_add_u32 v246, v2, 8, v4
    s_lshl_b32 s99, s40, 11
    s_mul_i32 s3, s40, 256
    s_add_u32 s3, s3, s46
    s_mul_i32 s3, s3, 4608
    s_and_b32 s4, s2, 1
    s_mul_i32 s4, s4, 512
    s_add_u32 s3, s3, s4
    v_min_u32 v2, 19, v1
    v_mul_u32_u24 v3, 205, v2
    v_lshrrev_b32 v3, 10, v3
    v_mul_u32_u24 v4, 5, v3
    v_sub_u32 v4, v2, v4
    v_mul_u32_u24 v3, 1152, v3
    v_lshl_add_u32 v3, v4, 7, v3
    v_add_u32 v255, s3, v3
    s_mov_b32 s93, s59
    s_mov_b32 s60, s24
    s_mov_b32 s61, s25
    s_mov_b32 s62, 4718592
    s_mov_b32 s63, 0x20000
    s_mul_i32 s3, s43, 6291456
    s_add_u32 s28, s88, s3
    s_addc_u32 s29, s89, 0
    s_mov_b32 s30, 6291456
    s_mov_b32 s31, 0x20000
    s_mov_b32 s36, s86
    s_mov_b32 s37, s87
    s_mov_b32 s38, 256
    s_mov_b32 s39, 0x20000
    s_and_b32 s56, s2, 1
    s_mul_i32 s57, s56, 5
    s_and_b32 s58, s46, 3
    s_add_u32 s57, s57, s58
    s_lshr_b32 s58, s46, 2
    s_mul_i32 s56, s56, 3
    s_add_u32 s56, s56, s46
    s_sub_u32 s56, s56, 24
    s_cmp_lt_u32 s46, 24
    s_cselect_b32 s90, s58, s56
    s_cselect_b32 s91, s57, 4
    s_bfe_u32 s3, s2, 0x10001
    s_mul_i32 s3, s3, 6
    s_add_u32 s90, s90, s3
    s_cmp_ge_u32 s46, 27
    s_cselect_b32 s92, 1, 0
    s_lshl_b32 s3, s91, 7
    s_add_u32 s24, s24, s3
    s_addc_u32 s25, s25, 0
    s_sub_u32 s26, 4718592, s3
    s_mov_b32 s27, 0x20000
    s_mov_b32 s59, s93
    v_accvgpr_write_b32 a64, 0
    v_accvgpr_write_b32 a65, 0
    v_accvgpr_write_b32 a66, 0
    v_accvgpr_write_b32 a67, 0
    v_accvgpr_write_b32 a68, 0
    v_accvgpr_write_b32 a69, 0
    v_accvgpr_write_b32 a70, 0
    v_accvgpr_write_b32 a71, 0
    v_accvgpr_write_b32 a72, 0
    v_accvgpr_write_b32 a73, 0
    v_accvgpr_write_b32 a74, 0
    v_accvgpr_write_b32 a75, 0
    v_accvgpr_write_b32 a76, 0
    v_accvgpr_write_b32 a77, 0
    v_accvgpr_write_b32 a78, 0
    v_accvgpr_write_b32 a79, 0
    v_accvgpr_write_b32 a80, 0
    v_accvgpr_write_b32 a81, 0
    v_accvgpr_write_b32 a82, 0
    v_accvgpr_write_b32 a83, 0
    v_accvgpr_write_b32 a84, 0
    v_accvgpr_write_b32 a85, 0
    v_accvgpr_write_b32 a86, 0
    v_accvgpr_write_b32 a87, 0
    v_accvgpr_write_b32 a88, 0
    v_accvgpr_write_b32 a89, 0
    v_accvgpr_write_b32 a90, 0
    v_accvgpr_write_b32 a91, 0
    v_accvgpr_write_b32 a92, 0
    v_accvgpr_write_b32 a93, 0
    v_accvgpr_write_b32 a94, 0
    v_accvgpr_write_b32 a95, 0
    v_accvgpr_write_b32 a96, 0
    v_accvgpr_write_b32 a97, 0
    v_accvgpr_write_b32 a98, 0
    v_accvgpr_write_b32 a99, 0
    v_accvgpr_write_b32 a100, 0
    v_accvgpr_write_b32 a101, 0
    v_accvgpr_write_b32 a102, 0
    v_accvgpr_write_b32 a103, 0
    v_accvgpr_write_b32 a104, 0
    v_accvgpr_write_b32 a105, 0
    v_accvgpr_write_b32 a106, 0
    v_accvgpr_write_b32 a107, 0
    v_accvgpr_write_b32 a108, 0
    v_accvgpr_write_b32 a109, 0
    v_accvgpr_write_b32 a110, 0
    v_accvgpr_write_b32 a111, 0
    v_accvgpr_write_b32 a112, 0
    v_accvgpr_write_b32 a113, 0
    v_accvgpr_write_b32 a114, 0
    v_accvgpr_write_b32 a115, 0
    v_accvgpr_write_b32 a116, 0
    v_accvgpr_write_b32 a117, 0
    v_accvgpr_write_b32 a118, 0
    v_accvgpr_write_b32 a119, 0
    v_accvgpr_write_b32 a120, 0
    v_accvgpr_write_b32 a121, 0
    v_accvgpr_write_b32 a122, 0
    v_accvgpr_write_b32 a123, 0
    v_accvgpr_write_b32 a124, 0
    v_accvgpr_write_b32 a125, 0
    v_accvgpr_write_b32 a126, 0
    v_accvgpr_write_b32 a127, 0
    v_accvgpr_write_b32 a128, 0
    v_accvgpr_write_b32 a129, 0
    v_accvgpr_write_b32 a130, 0
    v_accvgpr_write_b32 a131, 0
    v_accvgpr_write_b32 a132, 0
    v_accvgpr_write_b32 a133, 0
    v_accvgpr_write_b32 a134, 0
    v_accvgpr_write_b32 a135, 0
    v_accvgpr_write_b32 a136, 0
    v_accvgpr_write_b32 a137, 0
    v_accvgpr_write_b32 a138, 0
    v_accvgpr_write_b32 a139, 0
    v_accvgpr_write_b32 a140, 0
    v_accvgpr_write_b32 a141, 0
    v_accvgpr_write_b32 a142, 0
    v_accvgpr_write_b32 a143, 0
    v_accvgpr_write_b32 a144, 0
    v_accvgpr_write_b32 a145, 0
    v_accvgpr_write_b32 a146, 0
    v_accvgpr_write_b32 a147, 0
    v_accvgpr_write_b32 a148, 0
    v_accvgpr_write_b32 a149, 0
    v_accvgpr_write_b32 a150, 0
    v_accvgpr_write_b32 a151, 0
    v_accvgpr_write_b32 a152, 0
    v_accvgpr_write_b32 a153, 0
    v_accvgpr_write_b32 a154, 0
    v_accvgpr_write_b32 a155, 0
    v_accvgpr_write_b32 a156, 0
    v_accvgpr_write_b32 a157, 0
    v_accvgpr_write_b32 a158, 0
    v_accvgpr_write_b32 a159, 0
    v_accvgpr_write_b32 a160, 0
    v_accvgpr_write_b32 a161, 0
    v_accvgpr_write_b32 a162, 0
    v_accvgpr_write_b32 a163, 0
    v_accvgpr_write_b32 a164, 0
    v_accvgpr_write_b32 a165, 0
    v_accvgpr_write_b32 a166, 0
    v_accvgpr_write_b32 a167, 0
    v_accvgpr_write_b32 a168, 0
    v_accvgpr_write_b32 a169, 0
    v_accvgpr_write_b32 a170, 0
    v_accvgpr_write_b32 a171, 0
    v_accvgpr_write_b32 a172, 0
    v_accvgpr_write_b32 a173, 0
    v_accvgpr_write_b32 a174, 0
    v_accvgpr_write_b32 a175, 0
    v_accvgpr_write_b32 a176, 0
    v_accvgpr_write_b32 a177, 0
    v_accvgpr_write_b32 a178, 0
    v_accvgpr_write_b32 a179, 0
    v_accvgpr_write_b32 a180, 0
    v_accvgpr_write_b32 a181, 0
    v_accvgpr_write_b32 a182, 0
    v_accvgpr_write_b32 a183, 0
    v_accvgpr_write_b32 a184, 0
    v_accvgpr_write_b32 a185, 0
    v_accvgpr_write_b32 a186, 0
    v_accvgpr_write_b32 a187, 0
    v_accvgpr_write_b32 a188, 0
    v_accvgpr_write_b32 a189, 0
    v_accvgpr_write_b32 a190, 0
    v_accvgpr_write_b32 a191, 0
    s_mov_b32 s51, 0x49800000
    s_mov_b32 s52, 0x3e0293ee
    s_waitcnt vmcnt(5)
    s_barrier
    ds_read_b64_tr_b16 v[144:145], v116 offset:0
    ds_read_b64_tr_b16 v[146:147], v116 offset:512
    ds_read_b128 v[176:179], v112 offset:49152
    ds_read_b64_tr_b16 v[148:149], v117 offset:0
    ds_read_b64_tr_b16 v[150:151], v117 offset:512
    ds_read_b128 v[180:183], v112 offset:53248
    ds_read_b128 v[184:187], v112 offset:57344
    s_waitcnt lgkmcnt(4)
    v_mfma_f32_32x32x16_bf16 v[16:31], v[144:147], v[176:179], 0
    ds_read_b64_tr_b16 v[152:153], v116 offset:2048
    ds_read_b64_tr_b16 v[154:155], v116 offset:2560
    ds_read_b128 v[188:191], v113 offset:49152
    s_add_u32 m0, s59, 32768
    s_add_u32 s53, s53, 128
    s_cmp_eq_u32 s53, 1152
    s_cselect_b32 s53, 0, s53
    buffer_load_dwordx4 v122, s[8:11], s53 offen offset:0 lds
    buffer_load_dwordx4 v123, s[8:11], s53 offen offset:1024 lds
    s_waitcnt lgkmcnt(5)
    v_mfma_f32_32x32x16_bf16 v[32:47], v[148:151], v[176:179], 0
    ds_read_b64_tr_b16 v[156:157], v117 offset:2048
    ds_read_b64_tr_b16 v[158:159], v117 offset:2560
    buffer_load_dwordx4 v124, s[8:11], s53 offen offset:2048 lds
    s_add_u32 m0, s47, 131072
    s_add_u32 s100, s100, 262144
    s_cmp_eq_u32 s100, 4718592
    s_cselect_b32 s100, 0, s100
    buffer_load_dwordx4 v118, s[12:15], s100 offen offset:0 lds
    s_waitcnt lgkmcnt(6)
    v_mfma_f32_32x32x16_bf16 v[48:63], v[144:147], v[180:183], 0
    ds_read_b128 v[192:195], v113 offset:53248
    ds_read_b128 v[196:199], v113 offset:57344
    buffer_load_dwordx4 v119, s[12:15], s100 offen offset:1024 lds
    buffer_load_dwordx4 v120, s[12:15], s100 offen offset:2048 lds
    v_mfma_f32_32x32x16_bf16 v[64:79], v[148:151], v[180:183], 0
    buffer_load_dwordx4 v121, s[12:15], s100 offen offset:3072 lds
    s_add_u32 m0, s47, 147456
    s_add_u32 s100, s100, 262144
    s_cmp_eq_u32 s100, 4718592
    s_cselect_b32 s100, 0, s100
    buffer_load_dwordx4 v118, s[12:15], s100 offen offset:0 lds
    s_waitcnt lgkmcnt(7)
    v_mfma_f32_32x32x16_bf16 v[80:95], v[144:147], v[184:187], 0
    buffer_load_dwordx4 v119, s[12:15], s100 offen offset:1024 lds
    buffer_load_dwordx4 v120, s[12:15], s100 offen offset:2048 lds
    v_mfma_f32_32x32x16_bf16 v[96:111], v[148:151], v[184:187], 0
    buffer_load_dwordx4 v121, s[12:15], s100 offen offset:3072 lds
    s_add_u32 m0, s59, 49152
    s_add_u32 s53, s53, 128
    s_cmp_eq_u32 s53, 1152
    s_cselect_b32 s53, 0, s53
    buffer_load_dwordx4 v122, s[8:11], s53 offen offset:0 lds
    s_waitcnt lgkmcnt(2)
    v_mfma_f32_32x32x16_bf16 v[16:31], v[152:155], v[188:191], v[16:31]
    s_waitcnt vmcnt(13)
    ds_read_b64_tr_b16 v[144:145], v116 offset:16384
    ds_read_b64_tr_b16 v[146:147], v116 offset:16896
    ds_read_b128 v[176:179], v114 offset:49152
    buffer_load_dwordx4 v123, s[8:11], s53 offen offset:1024 lds
    buffer_load_dwordx4 v124, s[8:11], s53 offen offset:2048 lds
    v_mfma_f32_32x32x16_bf16 v[32:47], v[156:159], v[188:191], v[32:47]
    ds_read_b64_tr_b16 v[148:149], v117 offset:16384
    ds_read_b64_tr_b16 v[150:151], v117 offset:16896
    s_add_u32 m0, s47, 98304
    s_add_u32 s100, s100, 262144
    s_cmp_eq_u32 s100, 4718592
    s_cselect_b32 s100, 0, s100
    buffer_load_dwordx4 v118, s[12:15], s100 offen offset:0 lds
    buffer_load_dwordx4 v119, s[12:15], s100 offen offset:1024 lds
    s_waitcnt lgkmcnt(5)
    v_mfma_f32_32x32x16_bf16 v[48:63], v[152:155], v[192:195], v[48:63]
    ds_read_b128 v[180:183], v114 offset:53248
    ds_read_b128 v[184:187], v114 offset:57344
    buffer_load_dwordx4 v120, s[12:15], s100 offen offset:2048 lds
    buffer_load_dwordx4 v121, s[12:15], s100 offen offset:3072 lds
    v_mfma_f32_32x32x16_bf16 v[64:79], v[156:159], v[192:195], v[64:79]
    v_mfma_f32_32x32x16_bf16 v[80:95], v[152:155], v[196:199], v[80:95]
    v_mfma_f32_32x32x16_bf16 v[96:111], v[156:159], v[196:199], v[96:111]
    s_waitcnt vmcnt(15)
    s_barrier
    s_waitcnt lgkmcnt(2)
    v_mfma_f32_32x32x16_bf16 v[16:31], v[144:147], v[176:179], v[16:31]
    ds_read_b64_tr_b16 v[152:153], v116 offset:18432
    ds_read_b64_tr_b16 v[154:155], v116 offset:18944
    ds_read_b128 v[188:191], v115 offset:49152
    v_mfma_f32_32x32x16_bf16 v[32:47], v[148:151], v[176:179], v[32:47]
    ds_read_b64_tr_b16 v[156:157], v117 offset:18432
    ds_read_b64_tr_b16 v[158:159], v117 offset:18944
    s_waitcnt lgkmcnt(5)
    v_mfma_f32_32x32x16_bf16 v[48:63], v[144:147], v[180:183], v[48:63]
    ds_read_b128 v[192:195], v115 offset:53248
    ds_read_b128 v[196:199], v115 offset:57344
    v_mfma_f32_32x32x16_bf16 v[64:79], v[148:151], v[180:183], v[64:79]
    v_mfma_f32_32x32x16_bf16 v[80:95], v[144:147], v[184:187], v[80:95]
    v_mfma_f32_32x32x16_bf16 v[96:111], v[148:151], v[184:187], v[96:111]
    s_waitcnt lgkmcnt(2)
    v_mfma_f32_32x32x16_bf16 v[16:31], v[152:155], v[188:191], v[16:31]
    s_waitcnt vmcnt(11)
    ds_read_b64_tr_b16 v[144:145], v116 offset:32768
    ds_read_b64_tr_b16 v[146:147], v116 offset:33280
    ds_read_b128 v[176:179], v112 offset:0
    v_mfma_f32_32x32x16_bf16 v[32:47], v[156:159], v[188:191], v[32:47]
    ds_read_b64_tr_b16 v[148:149], v117 offset:32768
    ds_read_b64_tr_b16 v[150:151], v117 offset:33280
    s_waitcnt lgkmcnt(5)
    v_mfma_f32_32x32x16_bf16 v[48:63], v[152:155], v[192:195], v[48:63]
    ds_read_b128 v[180:183], v112 offset:4096
    ds_read_b128 v[184:187], v112 offset:8192
    s_add_u32 m0, s47, 114688
    s_add_u32 s100, s100, 262144
    s_cmp_eq_u32 s100, 4718592
    s_cselect_b32 s100, 0, s100
    buffer_load_dwordx4 v118, s[12:15], s100 offen offset:0 lds
    v_mfma_f32_32x32x16_bf16 v[64:79], v[156:159], v[192:195], v[64:79]
    buffer_load_dwordx4 v119, s[12:15], s100 offen offset:1024 lds
    v_mfma_f32_32x32x16_bf16 v[80:95], v[152:155], v[196:199], v[80:95]
    buffer_load_dwordx4 v120, s[12:15], s100 offen offset:2048 lds
    v_mfma_f32_32x32x16_bf16 v[96:111], v[156:159], v[196:199], v[96:111]
    buffer_load_dwordx4 v121, s[12:15], s100 offen offset:3072 lds
    s_waitcnt vmcnt(8)
    s_barrier
    s_waitcnt lgkmcnt(2)
    v_mfma_f32_32x32x16_bf16 v[16:31], v[144:147], v[176:179], v[16:31]
    ds_read_b64_tr_b16 v[152:153], v116 offset:34816
    ds_read_b64_tr_b16 v[154:155], v116 offset:35328
    ds_read_b128 v[188:191], v113 offset:0
    v_mfma_f32_32x32x16_bf16 v[32:47], v[148:151], v[176:179], v[32:47]
    ds_read_b64_tr_b16 v[156:157], v117 offset:34816
    ds_read_b64_tr_b16 v[158:159], v117 offset:35328
    s_add_u32 m0, s59, 81920
    s_add_u32 s53, s53, 128
    s_cmp_eq_u32 s53, 1152
    s_cselect_b32 s53, 0, s53
    buffer_load_dwordx4 v122, s[8:11], s53 offen offset:0 lds
    s_waitcnt lgkmcnt(5)
    v_mfma_f32_32x32x16_bf16 v[48:63], v[144:147], v[180:183], v[48:63]
    ds_read_b128 v[192:195], v113 offset:4096
    ds_read_b128 v[196:199], v113 offset:8192
    buffer_load_dwordx4 v123, s[8:11], s53 offen offset:1024 lds
    v_mfma_f32_32x32x16_bf16 v[64:79], v[148:151], v[180:183], v[64:79]
    buffer_load_dwordx4 v124, s[8:11], s53 offen offset:2048 lds
    v_mfma_f32_32x32x16_bf16 v[80:95], v[144:147], v[184:187], v[80:95]
    s_add_u32 s48, s99, 0
    s_pack_ll_b32_b16 m0, s48, 0
    s_nop 0
    buffer_load_dwordx4 v244, s[16:19], s48 offen nt lds
    v_mfma_f32_32x32x16_bf16 v[96:111], v[148:151], v[184:187], v[96:111]
    s_add_u32 s48, s99, 1024
    s_pack_ll_b32_b16 m0, s48, 0
    s_nop 0
    buffer_load_dwordx4 v244, s[16:19], s48 offen nt lds
    s_waitcnt lgkmcnt(2)
    v_mfma_f32_32x32x16_bf16 v[16:31], v[152:155], v[188:191], v[16:31]
    s_waitcnt vmcnt(16)
    ds_read_b64_tr_b16 v[144:145], v116 offset:49152
    ds_read_b64_tr_b16 v[146:147], v116 offset:49664
    ds_read_b128 v[176:179], v114 offset:0
    v_mfma_f32_32x32x16_bf16 v[32:47], v[156:159], v[188:191], v[32:47]
    ds_read_b64_tr_b16 v[148:149], v117 offset:49152
    ds_read_b64_tr_b16 v[150:151], v117 offset:49664
    s_waitcnt lgkmcnt(5)
    v_mfma_f32_32x32x16_bf16 v[48:63], v[152:155], v[192:195], v[48:63]
    ds_read_b128 v[180:183], v114 offset:4096
    ds_read_b128 v[184:187], v114 offset:8192
    s_add_u32 s48, s99, 8192
    s_pack_ll_b32_b16 m0, s48, 0
    s_nop 0
    buffer_load_dwordx4 v244, s[16:19], s48 offen nt lds
    v_mfma_f32_32x32x16_bf16 v[64:79], v[156:159], v[192:195], v[64:79]
    s_add_u32 s48, s99, 9216
    s_pack_ll_b32_b16 m0, s48, 0
    s_nop 0
    buffer_load_dwordx4 v244, s[16:19], s48 offen nt lds
    v_mfma_f32_32x32x16_bf16 v[80:95], v[152:155], v[196:199], v[80:95]
    s_add_u32 m0, s47, 131072
    s_add_u32 s100, s100, 262144
    s_cmp_eq_u32 s100, 4718592
    s_cselect_b32 s100, 0, s100
    buffer_load_dwordx4 v118, s[12:15], s100 offen offset:0 lds
    v_mfma_f32_32x32x16_bf16 v[96:111], v[156:159], v[196:199], v[96:111]
    buffer_load_dwordx4 v119, s[12:15], s100 offen offset:1024 lds
    s_waitcnt lgkmcnt(2)
    v_mfma_f32_32x32x16_bf16 v[16:31], v[144:147], v[176:179], v[16:31]
    ds_read_b64_tr_b16 v[152:153], v116 offset:51200
    ds_read_b64_tr_b16 v[154:155], v116 offset:51712
    ds_read_b128 v[188:191], v115 offset:0
    v_mfma_f32_32x32x16_bf16 v[32:47], v[148:151], v[176:179], v[32:47]
    ds_read_b64_tr_b16 v[156:157], v117 offset:51200
    ds_read_b64_tr_b16 v[158:159], v117 offset:51712
    s_waitcnt lgkmcnt(5)
    v_mfma_f32_32x32x16_bf16 v[48:63], v[144:147], v[180:183], v[48:63]
    ds_read_b128 v[192:195], v115 offset:4096
    ds_read_b128 v[196:199], v115 offset:8192
    buffer_load_dwordx4 v120, s[12:15], s100 offen offset:2048 lds
    v_mfma_f32_32x32x16_bf16 v[64:79], v[148:151], v[180:183], v[64:79]
    buffer_load_dwordx4 v121, s[12:15], s100 offen offset:3072 lds
    v_mfma_f32_32x32x16_bf16 v[80:95], v[144:147], v[184:187], v[80:95]
    v_mfma_f32_32x32x16_bf16 v[96:111], v[148:151], v[184:187], v[96:111]
    s_waitcnt lgkmcnt(2)
    v_mfma_f32_32x32x16_bf16 v[16:31], v[152:155], v[188:191], v[16:31]
    s_waitcnt vmcnt(15)
    ds_read_b64_tr_b16 v[144:145], v116 offset:0
    ds_read_b64_tr_b16 v[146:147], v116 offset:512
    ds_read_b128 v[176:179], v112 offset:16384
    v_mfma_f32_32x32x16_bf16 v[32:47], v[156:159], v[188:191], v[32:47]
    ds_read_b64_tr_b16 v[148:149], v117 offset:0
    ds_read_b64_tr_b16 v[150:151], v117 offset:512
    s_waitcnt lgkmcnt(5)
    v_mfma_f32_32x32x16_bf16 v[48:63], v[152:155], v[192:195], v[48:63]
    ds_read_b128 v[180:183], v112 offset:20480
    ds_read_b128 v[184:187], v112 offset:24576
    s_add_u32 m0, s47, 147456
    s_add_u32 s100, s100, 262144
    s_cmp_eq_u32 s100, 4718592
    s_cselect_b32 s100, 0, s100
    buffer_load_dwordx4 v118, s[12:15], s100 offen offset:0 lds
    v_mfma_f32_32x32x16_bf16 v[64:79], v[156:159], v[192:195], v[64:79]
    buffer_load_dwordx4 v119, s[12:15], s100 offen offset:1024 lds
    v_mfma_f32_32x32x16_bf16 v[80:95], v[152:155], v[196:199], v[80:95]
    buffer_load_dwordx4 v120, s[12:15], s100 offen offset:2048 lds
    v_mfma_f32_32x32x16_bf16 v[96:111], v[156:159], v[196:199], v[96:111]
    buffer_load_dwordx4 v121, s[12:15], s100 offen offset:3072 lds
    s_waitcnt vmcnt(12)
    s_barrier
    s_waitcnt lgkmcnt(2)
    v_mfma_f32_32x32x16_bf16 v[16:31], v[144:147], v[176:179], v[16:31]
    ds_read_b64_tr_b16 v[152:153], v116 offset:2048
    ds_read_b64_tr_b16 v[154:155], v116 offset:2560
    ds_read_b128 v[188:191], v113 offset:16384
    v_mfma_f32_32x32x16_bf16 v[32:47], v[148:151], v[176:179], v[32:47]
    ds_read_b64_tr_b16 v[156:157], v117 offset:2048
    ds_read_b64_tr_b16 v[158:159], v117 offset:2560
    s_add_u32 m0, s59, 32768
    s_add_u32 s53, s53, 128
    s_cmp_eq_u32 s53, 1152
    s_cselect_b32 s53, 0, s53
    buffer_load_dwordx4 v122, s[8:11], s53 offen offset:0 lds
    s_waitcnt lgkmcnt(5)
    v_mfma_f32_32x32x16_bf16 v[48:63], v[144:147], v[180:183], v[48:63]
    ds_read_b128 v[192:195], v113 offset:20480
    ds_read_b128 v[196:199], v113 offset:24576
    buffer_load_dwordx4 v123, s[8:11], s53 offen offset:1024 lds
    v_mfma_f32_32x32x16_bf16 v[64:79], v[148:151], v[180:183], v[64:79]
    buffer_load_dwordx4 v124, s[8:11], s53 offen offset:2048 lds
    v_mfma_f32_32x32x16_bf16 v[80:95], v[144:147], v[184:187], v[80:95]
    s_add_u32 s48, s99, 16384
    s_pack_ll_b32_b16 m0, s48, 0
    s_nop 0
    buffer_load_dwordx4 v244, s[16:19], s48 offen nt lds
    v_mfma_f32_32x32x16_bf16 v[96:111], v[148:151], v[184:187], v[96:111]
    s_add_u32 s48, s99, 17408
    s_pack_ll_b32_b16 m0, s48, 0
    s_nop 0
    buffer_load_dwordx4 v244, s[16:19], s48 offen nt lds
    s_waitcnt lgkmcnt(2)
    v_mfma_f32_32x32x16_bf16 v[16:31], v[152:155], v[188:191], v[16:31]
    s_waitcnt vmcnt(20)
    ds_read_b64_tr_b16 v[144:145], v116 offset:16384
    ds_read_b64_tr_b16 v[146:147], v116 offset:16896
    ds_read_b128 v[176:179], v114 offset:16384
    v_mfma_f32_32x32x16_bf16 v[32:47], v[156:159], v[188:191], v[32:47]
    ds_read_b64_tr_b16 v[148:149], v117 offset:16384
    ds_read_b64_tr_b16 v[150:151], v117 offset:16896
    s_waitcnt lgkmcnt(5)
    v_mfma_f32_32x32x16_bf16 v[48:63], v[152:155], v[192:195], v[48:63]
    ds_read_b128 v[180:183], v114 offset:20480
    ds_read_b128 v[184:187], v114 offset:24576
    s_add_u32 s48, s99, 24576
    s_pack_ll_b32_b16 m0, s48, 0
    s_nop 0
    buffer_load_dwordx4 v244, s[16:19], s48 offen nt lds
    v_mfma_f32_32x32x16_bf16 v[64:79], v[156:159], v[192:195], v[64:79]
    s_add_u32 s48, s99, 25600
    s_pack_ll_b32_b16 m0, s48, 0
    s_nop 0
    buffer_load_dwordx4 v244, s[16:19], s48 offen nt lds
    v_mfma_f32_32x32x16_bf16 v[80:95], v[152:155], v[196:199], v[80:95]
    s_add_u32 m0, s47, 98304
    s_add_u32 s100, s100, 262144
    s_cmp_eq_u32 s100, 4718592
    s_cselect_b32 s100, 0, s100
    buffer_load_dwordx4 v118, s[12:15], s100 offen offset:0 lds
    v_mfma_f32_32x32x16_bf16 v[96:111], v[156:159], v[196:199], v[96:111]
    buffer_load_dwordx4 v119, s[12:15], s100 offen offset:1024 lds
    s_waitcnt lgkmcnt(2)
    v_mfma_f32_32x32x16_bf16 v[16:31], v[144:147], v[176:179], v[16:31]
    ds_read_b64_tr_b16 v[152:153], v116 offset:18432
    ds_read_b64_tr_b16 v[154:155], v116 offset:18944
    ds_read_b128 v[188:191], v115 offset:16384
    v_mfma_f32_32x32x16_bf16 v[32:47], v[148:151], v[176:179], v[32:47]
    ds_read_b64_tr_b16 v[156:157], v117 offset:18432
    ds_read_b64_tr_b16 v[158:159], v117 offset:18944
    s_waitcnt lgkmcnt(5)
    v_mfma_f32_32x32x16_bf16 v[48:63], v[144:147], v[180:183], v[48:63]
    ds_read_b128 v[192:195], v115 offset:20480
    ds_read_b128 v[196:199], v115 offset:24576
    buffer_load_dwordx4 v120, s[12:15], s100 offen offset:2048 lds
    v_mfma_f32_32x32x16_bf16 v[64:79], v[148:151], v[180:183], v[64:79]
    buffer_load_dwordx4 v121, s[12:15], s100 offen offset:3072 lds
    v_mfma_f32_32x32x16_bf16 v[80:95], v[144:147], v[184:187], v[80:95]
    v_mfma_f32_32x32x16_bf16 v[96:111], v[148:151], v[184:187], v[96:111]
    s_waitcnt lgkmcnt(2)
    v_mfma_f32_32x32x16_bf16 v[16:31], v[152:155], v[188:191], v[16:31]
    s_waitcnt vmcnt(15)
    ds_read_b64_tr_b16 v[144:145], v116 offset:32768
    ds_read_b64_tr_b16 v[146:147], v116 offset:33280
    ds_read_b128 v[176:179], v112 offset:49152
    v_mfma_f32_32x32x16_bf16 v[32:47], v[156:159], v[188:191], v[32:47]
    ds_read_b64_tr_b16 v[148:149], v117 offset:32768
    ds_read_b64_tr_b16 v[150:151], v117 offset:33280
    s_waitcnt lgkmcnt(5)
    v_mfma_f32_32x32x16_bf16 v[48:63], v[152:155], v[192:195], v[48:63]
    ds_read_b128 v[180:183], v112 offset:53248
    ds_read_b128 v[184:187], v112 offset:57344
    s_add_u32 m0, s47, 114688
    s_add_u32 s100, s100, 262144
    s_cmp_eq_u32 s100, 4718592
    s_cselect_b32 s100, 0, s100
    buffer_load_dwordx4 v118, s[12:15], s100 offen offset:0 lds
    v_mfma_f32_32x32x16_bf16 v[64:79], v[156:159], v[192:195], v[64:79]
    buffer_load_dwordx4 v119, s[12:15], s100 offen offset:1024 lds
    v_mfma_f32_32x32x16_bf16 v[80:95], v[152:155], v[196:199], v[80:95]
    buffer_load_dwordx4 v120, s[12:15], s100 offen offset:2048 lds
    v_mfma_f32_32x32x16_bf16 v[96:111], v[156:159], v[196:199], v[96:111]
    buffer_load_dwordx4 v121, s[12:15], s100 offen offset:3072 lds
    s_waitcnt vmcnt(12)
    s_barrier
    s_waitcnt lgkmcnt(2)
    v_mfma_f32_32x32x16_bf16 v[16:31], v[144:147], v[176:179], v[16:31]
    ds_read_b64_tr_b16 v[152:153], v116 offset:34816
    ds_read_b64_tr_b16 v[154:155], v116 offset:35328
    ds_read_b128 v[188:191], v113 offset:49152
    v_mfma_f32_32x32x16_bf16 v[32:47], v[148:151], v[176:179], v[32:47]
    ds_read_b64_tr_b16 v[156:157], v117 offset:34816
    ds_read_b64_tr_b16 v[158:159], v117 offset:35328
    s_add_u32 m0, s59, 49152
    s_add_u32 s53, s53, 128
    s_cmp_eq_u32 s53, 1152
    s_cselect_b32 s53, 0, s53
    buffer_load_dwordx4 v122, s[8:11], s53 offen offset:0 lds
    s_waitcnt lgkmcnt(5)
    v_mfma_f32_32x32x16_bf16 v[48:63], v[144:147], v[180:183], v[48:63]
    ds_read_b128 v[192:195], v113 offset:53248
    ds_read_b128 v[196:199], v113 offset:57344
    buffer_load_dwordx4 v123, s[8:11], s53 offen offset:1024 lds
    v_mfma_f32_32x32x16_bf16 v[64:79], v[148:151], v[180:183], v[64:79]
    buffer_load_dwordx4 v124, s[8:11], s53 offen offset:2048 lds
    v_mfma_f32_32x32x16_bf16 v[80:95], v[144:147], v[184:187], v[80:95]
    s_add_u32 s49, s99, 0
    s_pack_ll_b32_b16 m0, s49, 1
    s_nop 0
    buffer_load_dwordx4 v246, s[20:23], s49 offen nt lds
    v_mfma_f32_32x32x16_bf16 v[96:111], v[148:151], v[184:187], v[96:111]
    s_add_u32 s49, s99, 1024
    s_pack_ll_b32_b16 m0, s49, 1
    s_nop 0
    buffer_load_dwordx4 v246, s[20:23], s49 offen nt lds
    s_waitcnt lgkmcnt(2)
    v_mfma_f32_32x32x16_bf16 v[16:31], v[152:155], v[188:191], v[16:31]
    s_waitcnt vmcnt(20)
    ds_read_b64_tr_b16 v[144:145], v116 offset:49152
    ds_read_b64_tr_b16 v[146:147], v116 offset:49664
    ds_read_b128 v[176:179], v114 offset:49152
    v_mfma_f32_32x32x16_bf16 v[32:47], v[156:159], v[188:191], v[32:47]
    ds_read_b64_tr_b16 v[148:149], v117 offset:49152
    ds_read_b64_tr_b16 v[150:151], v117 offset:49664
    s_waitcnt lgkmcnt(5)
    v_mfma_f32_32x32x16_bf16 v[48:63], v[152:155], v[192:195], v[48:63]
    ds_read_b128 v[180:183], v114 offset:53248
    ds_read_b128 v[184:187], v114 offset:57344
    s_add_u32 s49, s99, 8192
    s_pack_ll_b32_b16 m0, s49, 1
    s_nop 0
    buffer_load_dwordx4 v246, s[20:23], s49 offen nt lds
    v_mfma_f32_32x32x16_bf16 v[64:79], v[156:159], v[192:195], v[64:79]
    s_add_u32 s49, s99, 9216
    s_pack_ll_b32_b16 m0, s49, 1
    s_nop 0
    buffer_load_dwordx4 v246, s[20:23], s49 offen nt lds
    v_mfma_f32_32x32x16_bf16 v[80:95], v[152:155], v[196:199], v[80:95]
    s_add_u32 m0, s47, 131072
    s_add_u32 s100, s100, 262144
    s_cmp_eq_u32 s100, 4718592
    s_cselect_b32 s100, 0, s100
    buffer_load_dwordx4 v118, s[12:15], s100 offen offset:0 lds
    v_mfma_f32_32x32x16_bf16 v[96:111], v[156:159], v[196:199], v[96:111]
    buffer_load_dwordx4 v119, s[12:15], s100 offen offset:1024 lds
    s_waitcnt lgkmcnt(2)
    v_mfma_f32_32x32x16_bf16 v[16:31], v[144:147], v[176:179], v[16:31]
    ds_read_b64_tr_b16 v[152:153], v116 offset:51200
    ds_read_b64_tr_b16 v[154:155], v116 offset:51712
    ds_read_b128 v[188:191], v115 offset:49152
    v_mfma_f32_32x32x16_bf16 v[32:47], v[148:151], v[176:179], v[32:47]
    ds_read_b64_tr_b16 v[156:157], v117 offset:51200
    ds_read_b64_tr_b16 v[158:159], v117 offset:51712
    s_waitcnt lgkmcnt(5)
    v_mfma_f32_32x32x16_bf16 v[48:63], v[144:147], v[180:183], v[48:63]
    ds_read_b128 v[192:195], v115 offset:53248
    ds_read_b128 v[196:199], v115 offset:57344
    buffer_load_dwordx4 v120, s[12:15], s100 offen offset:2048 lds
    v_mfma_f32_32x32x16_bf16 v[64:79], v[148:151], v[180:183], v[64:79]
    buffer_load_dwordx4 v121, s[12:15], s100 offen offset:3072 lds
    v_mfma_f32_32x32x16_bf16 v[80:95], v[144:147], v[184:187], v[80:95]
    v_mfma_f32_32x32x16_bf16 v[96:111], v[148:151], v[184:187], v[96:111]
    s_waitcnt lgkmcnt(2)
    v_mfma_f32_32x32x16_bf16 v[16:31], v[152:155], v[188:191], v[16:31]
    s_waitcnt vmcnt(15)
    ds_read_b64_tr_b16 v[144:145], v116 offset:0
    ds_read_b64_tr_b16 v[146:147], v116 offset:512
    ds_read_b128 v[176:179], v112 offset:0
    v_mfma_f32_32x32x16_bf16 v[32:47], v[156:159], v[188:191], v[32:47]
    ds_read_b64_tr_b16 v[148:149], v117 offset:0
    ds_read_b64_tr_b16 v[150:151], v117 offset:512
    s_waitcnt lgkmcnt(5)
    v_mfma_f32_32x32x16_bf16 v[48:63], v[152:155], v[192:195], v[48:63]
    ds_read_b128 v[180:183], v112 offset:4096
    ds_read_b128 v[184:187], v112 offset:8192
    s_add_u32 m0, s47, 147456
    s_add_u32 s100, s100, 262144
    s_cmp_eq_u32 s100, 4718592
    s_cselect_b32 s100, 0, s100
    buffer_load_dwordx4 v118, s[12:15], s100 offen offset:0 lds
    v_mfma_f32_32x32x16_bf16 v[64:79], v[156:159], v[192:195], v[64:79]
    buffer_load_dwordx4 v119, s[12:15], s100 offen offset:1024 lds
    v_mfma_f32_32x32x16_bf16 v[80:95], v[152:155], v[196:199], v[80:95]
    buffer_load_dwordx4 v120, s[12:15], s100 offen offset:2048 lds
    v_mfma_f32_32x32x16_bf16 v[96:111], v[156:159], v[196:199], v[96:111]
    buffer_load_dwordx4 v121, s[12:15], s100 offen offset:3072 lds
    s_waitcnt vmcnt(12)
    s_barrier
    s_waitcnt lgkmcnt(2)
    v_mfma_f32_32x32x16_bf16 v[16:31], v[144:147], v[176:179], v[16:31]
    ds_read_b64_tr_b16 v[152:153], v116 offset:2048
    ds_read_b64_tr_b16 v[154:155], v116 offset:2560
    ds_read_b128 v[188:191], v113 offset:0
    v_mfma_f32_32x32x16_bf16 v[32:47], v[148:151], v[176:179], v[32:47]
    ds_read_b64_tr_b16 v[156:157], v117 offset:2048
    ds_read_b64_tr_b16 v[158:159], v117 offset:2560
    s_waitcnt lgkmcnt(5)
    v_mfma_f32_32x32x16_bf16 v[48:63], v[144:147], v[180:183], v[48:63]
    ds_read_b128 v[192:195], v113 offset:4096
    ds_read_b128 v[196:199], v113 offset:8192
    s_add_u32 m0, s59, 81920
    s_add_u32 s53, s53, 128
    s_cmp_eq_u32 s53, 1152
    s_cselect_b32 s53, 0, s53
    buffer_load_dwordx4 v122, s[8:11], s53 offen offset:0 lds
    v_mfma_f32_32x32x16_bf16 v[64:79], v[148:151], v[180:183], v[64:79]
    buffer_load_dwordx4 v123, s[8:11], s53 offen offset:1024 lds
    v_mfma_f32_32x32x16_bf16 v[80:95], v[144:147], v[184:187], v[80:95]
    buffer_load_dwordx4 v124, s[8:11], s53 offen offset:2048 lds
    v_mfma_f32_32x32x16_bf16 v[96:111], v[148:151], v[184:187], v[96:111]
    s_waitcnt lgkmcnt(2)
    v_mfma_f32_32x32x16_bf16 v[16:31], v[152:155], v[188:191], v[16:31]
    s_waitcnt vmcnt(18)
    ds_read_b64_tr_b16 v[144:145], v116 offset:16384
    ds_read_b64_tr_b16 v[146:147], v116 offset:16896
    ds_read_b128 v[176:179], v114 offset:0
    v_mfma_f32_32x32x16_bf16 v[32:47], v[156:159], v[188:191], v[32:47]
    ds_read_b64_tr_b16 v[148:149], v117 offset:16384
    ds_read_b64_tr_b16 v[150:151], v117 offset:16896
    s_waitcnt lgkmcnt(5)
    v_mfma_f32_32x32x16_bf16 v[48:63], v[152:155], v[192:195], v[48:63]
    ds_read_b128 v[180:183], v114 offset:4096
    ds_read_b128 v[184:187], v114 offset:8192
    s_add_u32 m0, s47, 98304
    s_add_u32 s100, s100, 262144
    s_cmp_eq_u32 s100, 4718592
    s_cselect_b32 s100, 0, s100
    buffer_load_dwordx4 v118, s[12:15], s100 offen offset:0 lds
    v_mfma_f32_32x32x16_bf16 v[64:79], v[156:159], v[192:195], v[64:79]
    buffer_load_dwordx4 v119, s[12:15], s100 offen offset:1024 lds
    v_mfma_f32_32x32x16_bf16 v[80:95], v[152:155], v[196:199], v[80:95]
    buffer_load_dwordx4 v120, s[12:15], s100 offen offset:2048 lds
    v_mfma_f32_32x32x16_bf16 v[96:111], v[156:159], v[196:199], v[96:111]
    buffer_load_dwordx4 v121, s[12:15], s100 offen offset:3072 lds
    s_waitcnt lgkmcnt(2)
    v_mfma_f32_32x32x16_bf16 v[16:31], v[144:147], v[176:179], v[16:31]
    ds_read_b64_tr_b16 v[152:153], v116 offset:18432
    ds_read_b64_tr_b16 v[154:155], v116 offset:18944
    ds_read_b128 v[188:191], v115 offset:0
    v_mfma_f32_32x32x16_bf16 v[32:47], v[148:151], v[176:179], v[32:47]
    ds_read_b64_tr_b16 v[156:157], v117 offset:18432
    ds_read_b64_tr_b16 v[158:159], v117 offset:18944
    s_waitcnt lgkmcnt(5)
    v_mfma_f32_32x32x16_bf16 v[48:63], v[144:147], v[180:183], v[48:63]
    ds_read_b128 v[192:195], v115 offset:4096
    ds_read_b128 v[196:199], v115 offset:8192
    v_mfma_f32_32x32x16_bf16 v[64:79], v[148:151], v[180:183], v[64:79]
    v_mfma_f32_32x32x16_bf16 v[80:95], v[144:147], v[184:187], v[80:95]
    v_mfma_f32_32x32x16_bf16 v[96:111], v[148:151], v[184:187], v[96:111]
    s_waitcnt lgkmcnt(2)
    v_mfma_f32_32x32x16_bf16 v[16:31], v[152:155], v[188:191], v[16:31]
    s_waitcnt vmcnt(11)
    ds_read_b64_tr_b16 v[144:145], v116 offset:32768
    ds_read_b64_tr_b16 v[146:147], v116 offset:33280
    ds_read_b128 v[176:179], v112 offset:16384
    v_mfma_f32_32x32x16_bf16 v[32:47], v[156:159], v[188:191], v[32:47]
    ds_read_b64_tr_b16 v[148:149], v117 offset:32768
    ds_read_b64_tr_b16 v[150:151], v117 offset:33280
    s_waitcnt lgkmcnt(5)
    v_mfma_f32_32x32x16_bf16 v[48:63], v[152:155], v[192:195], v[48:63]
    ds_read_b128 v[180:183], v112 offset:20480
    ds_read_b128 v[184:187], v112 offset:24576
    s_add_u32 m0, s47, 114688
    s_add_u32 s100, s100, 262144
    s_cmp_eq_u32 s100, 4718592
    s_cselect_b32 s100, 0, s100
    buffer_load_dwordx4 v118, s[12:15], s100 offen offset:0 lds
    v_mfma_f32_32x32x16_bf16 v[64:79], v[156:159], v[192:195], v[64:79]
    buffer_load_dwordx4 v119, s[12:15], s100 offen offset:1024 lds
    v_mfma_f32_32x32x16_bf16 v[80:95], v[152:155], v[196:199], v[80:95]
    buffer_load_dwordx4 v120, s[12:15], s100 offen offset:2048 lds
    v_mfma_f32_32x32x16_bf16 v[96:111], v[156:159], v[196:199], v[96:111]
    buffer_load_dwordx4 v121, s[12:15], s100 offen offset:3072 lds
    s_waitcnt vmcnt(8)
    s_barrier
    s_waitcnt lgkmcnt(2)
    v_mfma_f32_32x32x16_bf16 v[16:31], v[144:147], v[176:179], v[16:31]
    ds_read_b64_tr_b16 v[152:153], v116 offset:34816
    ds_read_b64_tr_b16 v[154:155], v116 offset:35328
    ds_read_b128 v[188:191], v113 offset:16384
    v_mfma_f32_32x32x16_bf16 v[32:47], v[148:151], v[176:179], v[32:47]
    ds_read_b64_tr_b16 v[156:157], v117 offset:34816
    ds_read_b64_tr_b16 v[158:159], v117 offset:35328
    s_waitcnt lgkmcnt(5)
    v_mfma_f32_32x32x16_bf16 v[48:63], v[144:147], v[180:183], v[48:63]
    ds_read_b128 v[192:195], v113 offset:20480
    ds_read_b128 v[196:199], v113 offset:24576
    s_add_u32 m0, s59, 32768
    s_add_u32 s53, s53, 128
    s_cmp_eq_u32 s53, 1152
    s_cselect_b32 s53, 0, s53
    buffer_load_dwordx4 v122, s[8:11], s53 offen offset:0 lds
    v_mfma_f32_32x32x16_bf16 v[64:79], v[148:151], v[180:183], v[64:79]
    buffer_load_dwordx4 v123, s[8:11], s53 offen offset:1024 lds
    v_mfma_f32_32x32x16_bf16 v[80:95], v[144:147], v[184:187], v[80:95]
    buffer_load_dwordx4 v124, s[8:11], s53 offen offset:2048 lds
    v_mfma_f32_32x32x16_bf16 v[96:111], v[148:151], v[184:187], v[96:111]
    s_waitcnt lgkmcnt(2)
    v_mfma_f32_32x32x16_bf16 v[16:31], v[152:155], v[188:191], v[16:31]
    s_waitcnt vmcnt(14)
    ds_read_b64_tr_b16 v[144:145], v116 offset:49152
    ds_read_b64_tr_b16 v[146:147], v116 offset:49664
    ds_read_b128 v[176:179], v114 offset:16384
    v_mfma_f32_32x32x16_bf16 v[32:47], v[156:159], v[188:191], v[32:47]
    ds_read_b64_tr_b16 v[148:149], v117 offset:49152
    ds_read_b64_tr_b16 v[150:151], v117 offset:49664
    s_waitcnt lgkmcnt(5)
    v_mfma_f32_32x32x16_bf16 v[48:63], v[152:155], v[192:195], v[48:63]
    ds_read_b128 v[180:183], v114 offset:20480
    ds_read_b128 v[184:187], v114 offset:24576
    s_add_u32 m0, s47, 131072
    s_add_u32 s100, s100, 262144
    s_cmp_eq_u32 s100, 4718592
    s_cselect_b32 s100, 0, s100
    buffer_load_dwordx4 v118, s[12:15], s100 offen offset:0 lds
    v_mfma_f32_32x32x16_bf16 v[64:79], v[156:159], v[192:195], v[64:79]
    buffer_load_dwordx4 v119, s[12:15], s100 offen offset:1024 lds
    v_mfma_f32_32x32x16_bf16 v[80:95], v[152:155], v[196:199], v[80:95]
    buffer_load_dwordx4 v120, s[12:15], s100 offen offset:2048 lds
    v_mfma_f32_32x32x16_bf16 v[96:111], v[156:159], v[196:199], v[96:111]
    buffer_load_dwordx4 v121, s[12:15], s100 offen offset:3072 lds
    s_waitcnt lgkmcnt(2)
    v_mfma_f32_32x32x16_bf16 v[16:31], v[144:147], v[176:179], v[16:31]
    ds_read_b64_tr_b16 v[152:153], v116 offset:51200
    ds_read_b64_tr_b16 v[154:155], v116 offset:51712
    ds_read_b128 v[188:191], v115 offset:16384
    v_mfma_f32_32x32x16_bf16 v[32:47], v[148:151], v[176:179], v[32:47]
    ds_read_b64_tr_b16 v[156:157], v117 offset:51200
    ds_read_b64_tr_b16 v[158:159], v117 offset:51712
    s_waitcnt lgkmcnt(5)
    v_mfma_f32_32x32x16_bf16 v[48:63], v[144:147], v[180:183], v[48:63]
    ds_read_b128 v[192:195], v115 offset:20480
    ds_read_b128 v[196:199], v115 offset:24576
    v_mfma_f32_32x32x16_bf16 v[64:79], v[148:151], v[180:183], v[64:79]
    v_mfma_f32_32x32x16_bf16 v[80:95], v[144:147], v[184:187], v[80:95]
    v_mfma_f32_32x32x16_bf16 v[96:111], v[148:151], v[184:187], v[96:111]
    s_waitcnt lgkmcnt(2)
    v_mfma_f32_32x32x16_bf16 v[16:31], v[152:155], v[188:191], v[16:31]
    s_waitcnt vmcnt(11)
    ds_read_b64_tr_b16 v[144:145], v116 offset:0
    ds_read_b64_tr_b16 v[146:147], v116 offset:512
    ds_read_b128 v[176:179], v112 offset:49152
    v_mfma_f32_32x32x16_bf16 v[32:47], v[156:159], v[188:191], v[32:47]
    ds_read_b64_tr_b16 v[148:149], v117 offset:0
    ds_read_b64_tr_b16 v[150:151], v117 offset:512
    s_waitcnt lgkmcnt(5)
    v_mfma_f32_32x32x16_bf16 v[48:63], v[152:155], v[192:195], v[48:63]
    ds_read_b128 v[180:183], v112 offset:53248
    ds_read_b128 v[184:187], v112 offset:57344
    s_add_u32 m0, s47, 147456
    s_add_u32 s100, s100, 262144
    s_cmp_eq_u32 s100, 4718592
    s_cselect_b32 s100, 0, s100
    buffer_load_dwordx4 v118, s[12:15], s100 offen offset:0 lds
    v_mfma_f32_32x32x16_bf16 v[64:79], v[156:159], v[192:195], v[64:79]
    buffer_load_dwordx4 v119, s[12:15], s100 offen offset:1024 lds
    v_mfma_f32_32x32x16_bf16 v[80:95], v[152:155], v[196:199], v[80:95]
    buffer_load_dwordx4 v120, s[12:15], s100 offen offset:2048 lds
    v_mfma_f32_32x32x16_bf16 v[96:111], v[156:159], v[196:199], v[96:111]
    buffer_load_dwordx4 v121, s[12:15], s100 offen offset:3072 lds
    s_waitcnt vmcnt(8)
    s_barrier
    s_waitcnt lgkmcnt(2)
    v_mfma_f32_32x32x16_bf16 v[16:31], v[144:147], v[176:179], v[16:31]
    ds_read_b64_tr_b16 v[152:153], v116 offset:2048
    ds_read_b64_tr_b16 v[154:155], v116 offset:2560
    ds_read_b128 v[188:191], v113 offset:49152
    v_mfma_f32_32x32x16_bf16 v[32:47], v[148:151], v[176:179], v[32:47]
    ds_read_b64_tr_b16 v[156:157], v117 offset:2048
    ds_read_b64_tr_b16 v[158:159], v117 offset:2560
    s_waitcnt lgkmcnt(5)
    v_mfma_f32_32x32x16_bf16 v[48:63], v[144:147], v[180:183], v[48:63]
    ds_read_b128 v[192:195], v113 offset:53248
    ds_read_b128 v[196:199], v113 offset:57344
    s_add_u32 m0, s59, 49152
    s_add_u32 s53, s53, 128
    s_cmp_eq_u32 s53, 1152
    s_cselect_b32 s53, 0, s53
    buffer_load_dwordx4 v122, s[8:11], s53 offen offset:0 lds
    v_mfma_f32_32x32x16_bf16 v[64:79], v[148:151], v[180:183], v[64:79]
    buffer_load_dwordx4 v123, s[8:11], s53 offen offset:1024 lds
    v_mfma_f32_32x32x16_bf16 v[80:95], v[144:147], v[184:187], v[80:95]
    buffer_load_dwordx4 v124, s[8:11], s53 offen offset:2048 lds
    v_mfma_f32_32x32x16_bf16 v[96:111], v[148:151], v[184:187], v[96:111]
    s_waitcnt lgkmcnt(2)
    v_mfma_f32_32x32x16_bf16 v[16:31], v[152:155], v[188:191], v[16:31]
    s_waitcnt vmcnt(14)
    ds_read_b64_tr_b16 v[144:145], v116 offset:16384
    ds_read_b64_tr_b16 v[146:147], v116 offset:16896
    ds_read_b128 v[176:179], v114 offset:49152
    v_mfma_f32_32x32x16_bf16 v[32:47], v[156:159], v[188:191], v[32:47]
    ds_read_b64_tr_b16 v[148:149], v117 offset:16384
    ds_read_b64_tr_b16 v[150:151], v117 offset:16896
    s_waitcnt lgkmcnt(5)
    v_mfma_f32_32x32x16_bf16 v[48:63], v[152:155], v[192:195], v[48:63]
    ds_read_b128 v[180:183], v114 offset:53248
    ds_read_b128 v[184:187], v114 offset:57344
    s_add_u32 m0, s47, 98304
    s_add_u32 s100, s100, 262144
    s_cmp_eq_u32 s100, 4718592
    s_cselect_b32 s100, 0, s100
    buffer_load_dwordx4 v118, s[12:15], s100 offen offset:0 lds
    v_mfma_f32_32x32x16_bf16 v[64:79], v[156:159], v[192:195], v[64:79]
    buffer_load_dwordx4 v119, s[12:15], s100 offen offset:1024 lds
    v_mfma_f32_32x32x16_bf16 v[80:95], v[152:155], v[196:199], v[80:95]
    buffer_load_dwordx4 v120, s[12:15], s100 offen offset:2048 lds
    v_mfma_f32_32x32x16_bf16 v[96:111], v[156:159], v[196:199], v[96:111]
    buffer_load_dwordx4 v121, s[12:15], s100 offen offset:3072 lds
    s_waitcnt lgkmcnt(2)
    v_mfma_f32_32x32x16_bf16 v[16:31], v[144:147], v[176:179], v[16:31]
    ds_read_b64_tr_b16 v[152:153], v116 offset:18432
    ds_read_b64_tr_b16 v[154:155], v116 offset:18944
    ds_read_b128 v[188:191], v115 offset:49152
    v_mfma_f32_32x32x16_bf16 v[32:47], v[148:151], v[176:179], v[32:47]
    ds_read_b64_tr_b16 v[156:157], v117 offset:18432
    ds_read_b64_tr_b16 v[158:159], v117 offset:18944
    s_waitcnt lgkmcnt(5)
    v_mfma_f32_32x32x16_bf16 v[48:63], v[144:147], v[180:183], v[48:63]
    ds_read_b128 v[192:195], v115 offset:53248
    ds_read_b128 v[196:199], v115 offset:57344
    v_mfma_f32_32x32x16_bf16 v[64:79], v[148:151], v[180:183], v[64:79]
    v_mfma_f32_32x32x16_bf16 v[80:95], v[144:147], v[184:187], v[80:95]
    v_mfma_f32_32x32x16_bf16 v[96:111], v[148:151], v[184:187], v[96:111]
    s_waitcnt lgkmcnt(2)
    v_mfma_f32_32x32x16_bf16 v[16:31], v[152:155], v[188:191], v[16:31]
    s_waitcnt vmcnt(11)
    ds_read_b64_tr_b16 v[144:145], v116 offset:32768
    ds_read_b64_tr_b16 v[146:147], v116 offset:33280
    ds_read_b128 v[176:179], v112 offset:0
    v_mfma_f32_32x32x16_bf16 v[32:47], v[156:159], v[188:191], v[32:47]
    ds_read_b64_tr_b16 v[148:149], v117 offset:32768
    ds_read_b64_tr_b16 v[150:151], v117 offset:33280
    s_waitcnt lgkmcnt(5)
    v_mfma_f32_32x32x16_bf16 v[48:63], v[152:155], v[192:195], v[48:63]
    ds_read_b128 v[180:183], v112 offset:4096
    ds_read_b128 v[184:187], v112 offset:8192
    s_add_u32 m0, s47, 114688
    s_add_u32 s100, s100, 262144
    s_cmp_eq_u32 s100, 4718592
    s_cselect_b32 s100, 0, s100
    buffer_load_dwordx4 v118, s[12:15], s100 offen offset:0 lds
    v_mfma_f32_32x32x16_bf16 v[64:79], v[156:159], v[192:195], v[64:79]
    buffer_load_dwordx4 v119, s[12:15], s100 offen offset:1024 lds
    v_mfma_f32_32x32x16_bf16 v[80:95], v[152:155], v[196:199], v[80:95]
    buffer_load_dwordx4 v120, s[12:15], s100 offen offset:2048 lds
    v_mfma_f32_32x32x16_bf16 v[96:111], v[156:159], v[196:199], v[96:111]
    buffer_load_dwordx4 v121, s[12:15], s100 offen offset:3072 lds
    s_waitcnt vmcnt(8)
    s_barrier
    s_waitcnt lgkmcnt(2)
    v_mfma_f32_32x32x16_bf16 v[16:31], v[144:147], v[176:179], v[16:31]
    ds_read_b64_tr_b16 v[152:153], v116 offset:34816
    ds_read_b64_tr_b16 v[154:155], v116 offset:35328
    ds_read_b128 v[188:191], v113 offset:0
    s_add_u32 s49, s99, 16384
    s_pack_ll_b32_b16 m0, s49, 1
    s_nop 0
    buffer_load_dwordx4 v246, s[20:23], s49 offen nt lds
    v_mfma_f32_32x32x16_bf16 v[32:47], v[148:151], v[176:179], v[32:47]
    ds_read_b64_tr_b16 v[156:157], v117 offset:34816
    ds_read_b64_tr_b16 v[158:159], v117 offset:35328
    s_waitcnt lgkmcnt(5)
    v_mfma_f32_32x32x16_bf16 v[48:63], v[144:147], v[180:183], v[48:63]
    ds_read_b128 v[192:195], v113 offset:4096
    ds_read_b128 v[196:199], v113 offset:8192
    v_mfma_f32_32x32x16_bf16 v[64:79], v[148:151], v[180:183], v[64:79]
    v_mfma_f32_32x32x16_bf16 v[80:95], v[144:147], v[184:187], v[80:95]
    v_mfma_f32_32x32x16_bf16 v[96:111], v[148:151], v[184:187], v[96:111]
    s_waitcnt lgkmcnt(2)
    v_mfma_f32_32x32x16_bf16 v[16:31], v[152:155], v[188:191], v[16:31]
    s_waitcnt vmcnt(12)
    ds_read_b64_tr_b16 v[144:145], v116 offset:49152
    ds_read_b64_tr_b16 v[146:147], v116 offset:49664
    ds_read_b128 v[176:179], v114 offset:0
    v_mfma_f32_32x32x16_bf16 v[32:47], v[156:159], v[188:191], v[32:47]
    ds_read_b64_tr_b16 v[148:149], v117 offset:49152
    ds_read_b64_tr_b16 v[150:151], v117 offset:49664
    s_add_u32 s49, s99, 17408
    s_pack_ll_b32_b16 m0, s49, 1
    s_nop 0
    buffer_load_dwordx4 v246, s[20:23], s49 offen nt lds
    s_waitcnt lgkmcnt(5)
    v_mfma_f32_32x32x16_bf16 v[48:63], v[152:155], v[192:195], v[48:63]
    ds_read_b128 v[180:183], v114 offset:4096
    ds_read_b128 v[184:187], v114 offset:8192
    v_mfma_f32_32x32x16_bf16 v[64:79], v[156:159], v[192:195], v[64:79]
    v_mfma_f32_32x32x16_bf16 v[80:95], v[152:155], v[196:199], v[80:95]
    v_mfma_f32_32x32x16_bf16 v[96:111], v[156:159], v[196:199], v[96:111]
    s_waitcnt lgkmcnt(2)
    v_mfma_f32_32x32x16_bf16 v[16:31], v[144:147], v[176:179], v[16:31]
    ds_read_b64_tr_b16 v[152:153], v116 offset:51200
    ds_read_b64_tr_b16 v[154:155], v116 offset:51712
    ds_read_b128 v[188:191], v115 offset:0
    v_mfma_f32_32x32x16_bf16 v[32:47], v[148:151], v[176:179], v[32:47]
    ds_read_b64_tr_b16 v[156:157], v117 offset:51200
    ds_read_b64_tr_b16 v[158:159], v117 offset:51712
    s_add_u32 s49, s99, 24576
    s_pack_ll_b32_b16 m0, s49, 1
    s_nop 0
    buffer_load_dwordx4 v246, s[20:23], s49 offen nt lds
    s_waitcnt lgkmcnt(5)
    v_mfma_f32_32x32x16_bf16 v[48:63], v[144:147], v[180:183], v[48:63]
    ds_read_b128 v[192:195], v115 offset:4096
    ds_read_b128 v[196:199], v115 offset:8192
    v_mfma_f32_32x32x16_bf16 v[64:79], v[148:151], v[180:183], v[64:79]
    v_mfma_f32_32x32x16_bf16 v[80:95], v[144:147], v[184:187], v[80:95]
    v_mfma_f32_32x32x16_bf16 v[96:111], v[148:151], v[184:187], v[96:111]
    s_waitcnt lgkmcnt(2)
    v_mfma_f32_32x32x16_bf16 v[16:31], v[152:155], v[188:191], v[16:31]
    s_waitcnt vmcnt(7)
    ds_read_b64_tr_b16 v[144:145], v116 offset:0
    ds_read_b64_tr_b16 v[146:147], v116 offset:512
    ds_read_b64_tr_b16 v[148:149], v117 offset:0
    ds_read_b64_tr_b16 v[150:151], v117 offset:512
    ds_read_b128 v[176:179], v112 offset:16384
    v_mfma_f32_32x32x16_bf16 v[32:47], v[156:159], v[188:191], v[32:47]
    ds_read_b64_tr_b16 v[160:161], v116 offset:2048
    ds_read_b64_tr_b16 v[162:163], v116 offset:2560
    ds_read_b64_tr_b16 v[164:165], v117 offset:2048
    ds_read_b64_tr_b16 v[166:167], v117 offset:2560
    s_waitcnt lgkmcnt(9)
    v_mfma_f32_32x32x16_bf16 v[48:63], v[152:155], v[192:195], v[48:63]
    ds_read_b128 v[180:183], v113 offset:16384
    ds_read_b128 v[184:187], v114 offset:16384
    s_add_u32 s49, s99, 25600
    s_pack_ll_b32_b16 m0, s49, 1
    s_nop 0
    buffer_load_dwordx4 v246, s[20:23], s49 offen nt lds
    v_mfma_f32_32x32x16_bf16 v[64:79], v[156:159], v[192:195], v[64:79]
    s_waitcnt vmcnt(4)
    ds_read_b64_tr_b16 v[168:169], v116 offset:16384
    ds_read_b64_tr_b16 v[170:171], v116 offset:16896
    ds_read_b64_tr_b16 v[172:173], v117 offset:16384
    ds_read_b64_tr_b16 v[174:175], v117 offset:16896
    v_mfma_f32_32x32x16_bf16 v[80:95], v[152:155], v[196:199], v[80:95]
    ds_read_b128 v[136:139], v115 offset:16384
    v_mfma_f32_32x32x16_bf16 v[96:111], v[156:159], v[196:199], v[96:111]
    s_waitcnt lgkmcnt(7)
    v_mfma_f32_32x32x16_bf16 v[16:31], v[144:147], v[176:179], v[16:31]
    ds_read_b64_tr_b16 v[152:153], v116 offset:18432
    ds_read_b64_tr_b16 v[154:155], v116 offset:18944
    ds_read_b64_tr_b16 v[156:157], v117 offset:18432
    ds_read_b64_tr_b16 v[158:159], v117 offset:18944
    v_lshlrev_b32 v14, 4, v1
    s_add_u32 s3, s47, 114688
    v_add_u32 v14, s3, v14
    v_xor_b32 v15, 0x2000, v14
    v_mfma_f32_32x32x16_bf16 v[32:47], v[148:151], v[176:179], v[32:47]
    ds_read_b128 v[188:191], v112 offset:20480
    ds_read_b128 v[192:195], v113 offset:20480
    ds_read_b128 v[196:199], v114 offset:20480
    ds_read_b128 v[140:143], v115 offset:20480
    s_waitcnt lgkmcnt(9)
    v_mfma_f32_32x32x16_bf16 v[16:31], v[160:163], v[180:183], v[16:31]
    v_mfma_f32_32x32x16_bf16 v[32:47], v[164:167], v[180:183], v[32:47]
    v_mfma_f32_32x32x16_bf16 v[16:31], v[168:171], v[184:187], v[16:31]
    v_mfma_f32_32x32x16_bf16 v[32:47], v[172:175], v[184:187], v[32:47]
    s_waitcnt lgkmcnt(0)
    v_mfma_f32_32x32x16_bf16 v[16:31], v[152:155], v[136:139], v[16:31]
    v_mfma_f32_32x32x16_bf16 v[32:47], v[156:159], v[136:139], v[32:47]
    v_mfma_f32_32x32x16_bf16 v[48:63], v[144:147], v[188:191], v[48:63]
    ds_read_b128 v[176:179], v112 offset:24576
    ds_read_b128 v[180:183], v113 offset:24576
    ds_read_b128 v[184:187], v114 offset:24576
    ds_read_b128 v[136:139], v115 offset:24576
    v_mfma_f32_32x32x16_bf16 v[64:79], v[148:151], v[188:191], v[64:79]
    v_mfma_f32_32x32x16_bf16 v[48:63], v[160:163], v[192:195], v[48:63]
    v_mfma_f32_32x32x16_bf16 v[64:79], v[164:167], v[192:195], v[64:79]
    s_nop 2
    v_mul_f32 v16, s52, v16
    v_mul_f32 v17, s52, v17
    v_mul_f32 v18, s52, v18
    v_mul_f32 v19, s52, v19
    v_mul_f32 v20, s52, v20
    v_mul_f32 v21, s52, v21
    v_mul_f32 v22, s52, v22
    v_mul_f32 v23, s52, v23
    v_cvt_pk_bf16_f32 v200, v16, v17
    v_cvt_pk_bf16_f32 v201, v18, v19
    v_cvt_pk_bf16_f32 v202, v20, v21
    v_mfma_f32_32x32x16_bf16 v[48:63], v[168:171], v[196:199], v[48:63]
    v_cvt_pk_bf16_f32 v203, v22, v23
    ds_write_b128 v14, v[200:203] offset:0
    v_mul_f32 v24, s52, v24
    v_mul_f32 v25, s52, v25
    v_mul_f32 v26, s52, v26
    v_mul_f32 v27, s52, v27
    v_mul_f32 v28, s52, v28
    v_mul_f32 v29, s52, v29
    v_mul_f32 v30, s52, v30
    v_mul_f32 v31, s52, v31
    v_cvt_pk_bf16_f32 v204, v24, v25
    v_mfma_f32_32x32x16_bf16 v[64:79], v[172:175], v[196:199], v[64:79]
    v_cvt_pk_bf16_f32 v205, v26, v27
    v_cvt_pk_bf16_f32 v206, v28, v29
    v_cvt_pk_bf16_f32 v207, v30, v31
    ds_write_b128 v14, v[204:207] offset:1024
    v_mul_f32 v32, s52, v32
    v_mul_f32 v33, s52, v33
    v_mul_f32 v34, s52, v34
    v_mul_f32 v35, s52, v35
    v_mul_f32 v36, s52, v36
    v_mul_f32 v37, s52, v37
    v_mul_f32 v38, s52, v38
    v_mfma_f32_32x32x16_bf16 v[48:63], v[152:155], v[140:143], v[48:63]
    v_mul_f32 v39, s52, v39
    v_cvt_pk_bf16_f32 v208, v32, v33
    v_cvt_pk_bf16_f32 v209, v34, v35
    v_cvt_pk_bf16_f32 v210, v36, v37
    v_cvt_pk_bf16_f32 v211, v38, v39
    ds_write_b128 v14, v[208:211] offset:2048
    v_mul_f32 v40, s52, v40
    v_mul_f32 v41, s52, v41
    v_mul_f32 v42, s52, v42
    v_mul_f32 v43, s52, v43
    v_mul_f32 v44, s52, v44
    v_mfma_f32_32x32x16_bf16 v[64:79], v[156:159], v[140:143], v[64:79]
    v_mul_f32 v45, s52, v45
    v_mul_f32 v46, s52, v46
    v_mul_f32 v47, s52, v47
    v_cvt_pk_bf16_f32 v212, v40, v41
    v_cvt_pk_bf16_f32 v213, v42, v43
    v_cvt_pk_bf16_f32 v214, v44, v45
    v_cvt_pk_bf16_f32 v215, v46, v47
    ds_write_b128 v14, v[212:215] offset:3072
    s_waitcnt lgkmcnt(4)
    v_mfma_f32_32x32x16_bf16 v[80:95], v[144:147], v[176:179], v[80:95]
    s_waitcnt vmcnt(63)
    s_waitcnt lgkmcnt(0)
    s_barrier
    ds_read_b128 v[112:115], v232 offset:0
    ds_read_b128 v[116:119], v233 offset:0
    ds_read_b128 a[192:195], v15 offset:0
    ds_read_b128 a[196:199], v15 offset:1024
    ds_read_b128 a[200:203], v15 offset:2048
    ds_read_b128 a[204:207], v15 offset:3072
    ds_read_b128 v[120:123], v234 offset:0
    ds_read_b128 v[124:127], v235 offset:0
    ds_read_b128 v[128:131], v236 offset:0
    ds_read_b128 v[132:135], v237 offset:0
    v_mfma_f32_32x32x16_bf16 v[96:111], v[148:151], v[176:179], v[96:111]
    s_add_u32 s48, s99, 32768
    s_pack_ll_b32_b16 m0, s48, 0
    s_nop 0
    buffer_load_dwordx4 v244, s[16:19], s48 offen nt lds
    v_mfma_f32_32x32x16_bf16 v[80:95], v[160:163], v[180:183], v[80:95]
    s_add_u32 s48, s99, 33792
    s_pack_ll_b32_b16 m0, s48, 0
    s_nop 0
    buffer_load_dwordx4 v244, s[16:19], s48 offen nt lds
    v_mfma_f32_32x32x16_bf16 v[96:111], v[164:167], v[180:183], v[96:111]
    s_add_u32 s48, s99, 40960
    s_pack_ll_b32_b16 m0, s48, 0
    s_nop 0
    buffer_load_dwordx4 v244, s[16:19], s48 offen nt lds
    v_mul_f32 v48, s52, v48
    v_mul_f32 v49, s52, v49
    v_mul_f32 v50, s52, v50
    v_mul_f32 v51, s52, v51
    v_mul_f32 v52, s52, v52
    v_mul_f32 v53, s52, v53
    v_mul_f32 v54, s52, v54
    v_mul_f32 v55, s52, v55
    v_cvt_pk_bf16_f32 v216, v48, v49
    v_mfma_f32_32x32x16_bf16 v[80:95], v[168:171], v[184:187], v[80:95]
    s_add_u32 s48, s99, 41984
    s_pack_ll_b32_b16 m0, s48, 0
    s_nop 0
    buffer_load_dwordx4 v244, s[16:19], s48 offen nt lds
    v_cvt_pk_bf16_f32 v217, v50, v51
    v_cvt_pk_bf16_f32 v218, v52, v53
    v_cvt_pk_bf16_f32 v219, v54, v55
    ds_write_b128 v14, v[216:219] offset:16384
    v_mul_f32 v56, s52, v56
    v_mul_f32 v57, s52, v57
    v_mul_f32 v58, s52, v58
    v_mul_f32 v59, s52, v59
    v_mul_f32 v60, s52, v60
    v_mfma_f32_32x32x16_bf16 v[96:111], v[172:175], v[184:187], v[96:111]
    v_mul_f32 v61, s52, v61
    v_mul_f32 v62, s52, v62
    v_mul_f32 v63, s52, v63
    v_cvt_pk_bf16_f32 v220, v56, v57
    v_cvt_pk_bf16_f32 v221, v58, v59
    v_cvt_pk_bf16_f32 v222, v60, v61
    v_cvt_pk_bf16_f32 v223, v62, v63
    ds_write_b128 v14, v[220:223] offset:17408
    v_mul_f32 v64, s52, v64
    v_mul_f32 v65, s52, v65
    v_mul_f32 v66, s52, v66
    v_mfma_f32_32x32x16_bf16 v[80:95], v[152:155], v[136:139], v[80:95]
    s_add_u32 s49, s99, 32768
    s_pack_ll_b32_b16 m0, s49, 1
    s_nop 0
    buffer_load_dwordx4 v246, s[20:23], s49 offen nt lds
    v_mul_f32 v67, s52, v67
    v_mul_f32 v68, s52, v68
    v_mul_f32 v69, s52, v69
    v_mul_f32 v70, s52, v70
    v_mul_f32 v71, s52, v71
    v_cvt_pk_bf16_f32 v224, v64, v65
    v_cvt_pk_bf16_f32 v225, v66, v67
    v_cvt_pk_bf16_f32 v226, v68, v69
    v_cvt_pk_bf16_f32 v227, v70, v71
    v_mfma_f32_32x32x16_bf16 v[96:111], v[156:159], v[136:139], v[96:111]
    ds_write_b128 v14, v[224:227] offset:18432
    v_mul_f32 v72, s52, v72
    v_mul_f32 v73, s52, v73
    v_mul_f32 v74, s52, v74
    v_mul_f32 v75, s52, v75
    v_mul_f32 v76, s52, v76
    v_mul_f32 v77, s52, v77
    v_mul_f32 v78, s52, v78
    v_mul_f32 v79, s52, v79
    v_cvt_pk_bf16_f32 v228, v72, v73
    v_cvt_pk_bf16_f32 v229, v74, v75
    s_waitcnt lgkmcnt(3)
    v_mfma_f32_32x32x16_bf16 v[16:31], v[112:115], v[200:203], 0
    v_cvt_pk_bf16_f32 v230, v76, v77
    v_cvt_pk_bf16_f32 v231, v78, v79
    ds_write_b128 v14, v[228:231] offset:19456
    ds_read_b128 v[136:139], v238 offset:0
    ds_read_b128 v[140:143], v239 offset:0
    v_mfma_f32_32x32x16_bf16 v[16:31], v[116:119], v[204:207], v[16:31]
    v_mfma_f32_32x32x16_bf16 v[16:31], v[120:123], v[208:211], v[16:31]
    s_add_u32 s49, s99, 33792
    s_pack_ll_b32_b16 m0, s49, 1
    s_nop 0
    buffer_load_dwordx4 v246, s[20:23], s49 offen nt lds
    s_waitcnt lgkmcnt(0)
    s_barrier
    ds_read_b128 a[208:211], v15 offset:16384
    ds_read_b128 a[212:215], v15 offset:17408
    ds_read_b128 a[216:219], v15 offset:18432
    ds_read_b128 a[220:223], v15 offset:19456
    v_mfma_f32_32x32x16_bf16 v[16:31], v[124:127], v[212:215], v[16:31]
    v_mul_f32 v80, s52, v80
    v_mul_f32 v81, s52, v81
    v_mul_f32 v82, s52, v82
    v_mul_f32 v83, s52, v83
    v_mul_f32 v84, s52, v84
    v_mul_f32 v85, s52, v85
    v_mul_f32 v86, s52, v86
    v_mul_f32 v87, s52, v87
    v_cvt_pk_bf16_f32 v176, v80, v81
    v_cvt_pk_bf16_f32 v177, v82, v83
    v_cvt_pk_bf16_f32 v178, v84, v85
    v_mfma_f32_32x32x16_bf16 v[16:31], v[128:131], a[192:195], v[16:31]
    v_cvt_pk_bf16_f32 v179, v86, v87
    ds_write_b128 v14, v[176:179] offset:32768
    v_mul_f32 v88, s52, v88
    v_mul_f32 v89, s52, v89
    v_mul_f32 v90, s52, v90
    v_mul_f32 v91, s52, v91
    v_mul_f32 v92, s52, v92
    v_mul_f32 v93, s52, v93
    v_mul_f32 v94, s52, v94
    v_mul_f32 v95, s52, v95
    v_cvt_pk_bf16_f32 v180, v88, v89
    v_mfma_f32_32x32x16_bf16 v[16:31], v[132:135], a[196:199], v[16:31]
    v_cvt_pk_bf16_f32 v181, v90, v91
    v_cvt_pk_bf16_f32 v182, v92, v93
    v_cvt_pk_bf16_f32 v183, v94, v95
    ds_write_b128 v14, v[180:183] offset:33792
    v_mul_f32 v96, s52, v96
    v_mul_f32 v97, s52, v97
    v_mul_f32 v98, s52, v98
    v_mul_f32 v99, s52, v99
    v_mul_f32 v100, s52, v100
    v_mul_f32 v101, s52, v101
    v_mul_f32 v102, s52, v102
    v_mfma_f32_32x32x16_bf16 v[16:31], v[136:139], a[200:203], v[16:31]
    s_add_u32 s49, s99, 40960
    s_pack_ll_b32_b16 m0, s49, 1
    s_nop 0
    buffer_load_dwordx4 v246, s[20:23], s49 offen nt lds
    v_mul_f32 v103, s52, v103
    v_cvt_pk_bf16_f32 v184, v96, v97
    v_cvt_pk_bf16_f32 v185, v98, v99
    v_cvt_pk_bf16_f32 v186, v100, v101
    v_cvt_pk_bf16_f32 v187, v102, v103
    ds_write_b128 v14, v[184:187] offset:34816
    v_mul_f32 v104, s52, v104
    v_mul_f32 v105, s52, v105
    v_mul_f32 v106, s52, v106
    v_mfma_f32_32x32x16_bf16 v[16:31], v[140:143], a[204:207], v[16:31]
    v_mul_f32 v107, s52, v107
    v_mul_f32 v108, s52, v108
    v_mul_f32 v109, s52, v109
    v_mul_f32 v110, s52, v110
    v_mul_f32 v111, s52, v111
    v_cvt_pk_bf16_f32 v188, v104, v105
    v_cvt_pk_bf16_f32 v189, v106, v107
    v_cvt_pk_bf16_f32 v190, v108, v109
    v_cvt_pk_bf16_f32 v191, v110, v111
    ds_write_b128 v14, v[188:191] offset:35840
    ds_read_b128 a[240:243], v14 offset:32768
    v_mfma_f32_32x32x16_bf16 v[32:47], v[112:115], v[216:219], 0
    ds_read_b128 a[244:247], v14 offset:33792
    ds_read_b128 a[248:251], v14 offset:34816
    ds_read_b128 a[252:255], v14 offset:35840
    v_mfma_f32_32x32x16_bf16 v[32:47], v[116:119], v[220:223], v[32:47]
    v_mfma_f32_32x32x16_bf16 v[32:47], v[120:123], v[224:227], v[32:47]
    s_waitcnt vmcnt(52)
    s_waitcnt lgkmcnt(0)
    s_barrier
    ds_read_b128 a[224:227], v15 offset:32768
    ds_read_b128 a[228:231], v15 offset:33792
    ds_read_b128 a[232:235], v15 offset:34816
    ds_read_b128 a[236:239], v15 offset:35840
    v_mfma_f32_32x32x16_bf16 v[32:47], v[124:127], v[228:231], v[32:47]
    s_add_u32 s49, s99, 41984
    s_pack_ll_b32_b16 m0, s49, 1
    s_nop 0
    buffer_load_dwordx4 v246, s[20:23], s49 offen nt lds
    v_max3_f32 v8, v16, v17, v18
    v_max3_f32 v8, v8, v19, v20
    v_max3_f32 v8, v8, v21, v22
    v_max3_f32 v8, v8, v23, v24
    v_max3_f32 v8, v8, v25, v26
    v_max3_f32 v8, v8, v27, v28
    v_max3_f32 v8, v8, v29, v30
    v_max_f32 v8, v8, v31
    v_mov_b32 v9, v8
    v_mfma_f32_32x32x16_bf16 v[32:47], v[128:131], a[208:211], v[32:47]
    s_nop 1
    v_permlane32_swap_b32 v8, v9
    v_max_f32 v8, v8, v9
    v_sub_f32 v64, 0, v8
    v_sub_f32 v16, v16, v8
    v_sub_f32 v17, v17, v8
    v_sub_f32 v18, v18, v8
    v_sub_f32 v19, v19, v8
    v_sub_f32 v20, v20, v8
    v_sub_f32 v21, v21, v8
    v_sub_f32 v22, v22, v8
    v_mfma_f32_32x32x16_bf16 v[32:47], v[132:135], a[212:215], v[32:47]
    v_sub_f32 v23, v23, v8
    v_sub_f32 v24, v24, v8
    v_sub_f32 v25, v25, v8
    v_sub_f32 v26, v26, v8
    v_sub_f32 v27, v27, v8
    v_sub_f32 v28, v28, v8
    v_sub_f32 v29, v29, v8
    v_sub_f32 v30, v30, v8
    v_sub_f32 v31, v31, v8
    v_mov_b32 v65, v64
    v_mov_b32 v66, v64
    v_mfma_f32_32x32x16_bf16 v[32:47], v[136:139], a[216:219], v[32:47]
    v_mov_b32 v67, v64
    v_mov_b32 v68, v64
    v_mov_b32 v69, v64
    v_mov_b32 v70, v64
    v_mov_b32 v71, v64
    v_mov_b32 v72, v64
    v_mov_b32 v73, v64
    v_mov_b32 v74, v64
    v_mov_b32 v75, v64
    v_mov_b32 v76, v64
    v_mov_b32 v77, v64
    v_mfma_f32_32x32x16_bf16 v[32:47], v[140:143], a[220:223], v[32:47]
    s_add_u32 s48, s99, 49152
    s_pack_ll_b32_b16 m0, s48, 0
    s_nop 0
    buffer_load_dwordx4 v244, s[16:19], s48 offen nt lds
    v_mov_b32 v78, v64
    v_mov_b32 v79, v64
    v_mov_b32 v247, 0
    ds_read_b64_tr_b16 v[144:145], v240 offset:0
    ds_read_b64_tr_b16 v[146:147], v240 offset:2048
    ds_read_b64_tr_b16 v[148:149], v241 offset:0
    ds_read_b64_tr_b16 v[150:151], v241 offset:2048
    ds_read_b64_tr_b16 v[152:153], v242 offset:0
    ds_read_b64_tr_b16 v[154:155], v242 offset:2048
    v_mfma_f32_32x32x16_bf16 v[48:63], v[112:115], a[240:243], 0
    ds_read_b64_tr_b16 v[156:157], v243 offset:0
    ds_read_b64_tr_b16 v[158:159], v243 offset:2048
    ds_read_b64_tr_b16 v[160:161], v240 offset:4096
    ds_read_b64_tr_b16 v[162:163], v240 offset:6144
    ds_read_b64_tr_b16 v[164:165], v241 offset:4096
    ds_read_b64_tr_b16 v[166:167], v241 offset:6144
    ds_read_b64_tr_b16 v[168:169], v242 offset:4096
    ds_read_b64_tr_b16 v[170:171], v242 offset:6144
    ds_read_b64_tr_b16 v[172:173], v243 offset:4096
    ds_read_b64_tr_b16 v[174:175], v243 offset:6144
    v_exp_f32 v4, v16
    v_mfma_f32_32x32x16_bf16 v[48:63], v[116:119], a[244:247], v[48:63]
    v_exp_f32 v5, v17
    v_exp_f32 v6, v18
    v_add_f32 v250, v4, v5
    v_cvt_pk_bf16_f32 v176, v4, v5
    v_exp_f32 v7, v19
    v_add_f32 v250, v250, v6
    v_exp_f32 v4, v20
    v_mfma_f32_32x32x16_bf16 v[48:63], v[120:123], a[248:251], v[48:63]
    v_add_f32 v250, v250, v7
    v_cvt_pk_bf16_f32 v177, v6, v7
    v_exp_f32 v5, v21
    v_add_f32 v250, v250, v4
    v_exp_f32 v6, v22
    v_add_f32 v250, v250, v5
    v_cvt_pk_bf16_f32 v178, v4, v5
    v_exp_f32 v7, v23
    v_mfma_f32_32x32x16_bf16 v[48:63], v[124:127], a[252:255], v[48:63]
    s_add_u32 s48, s99, 50176
    s_pack_ll_b32_b16 m0, s48, 0
    s_nop 0
    buffer_load_dwordx4 v244, s[16:19], s48 offen nt lds
    v_add_f32 v250, v250, v6
    v_exp_f32 v4, v24
    v_add_f32 v250, v250, v7
    v_cvt_pk_bf16_f32 v179, v6, v7
    v_exp_f32 v5, v25
    v_add_f32 v250, v250, v4
    v_exp_f32 v6, v26
    s_waitcnt lgkmcnt(10)
    v_mfma_f32_32x32x16_bf16 v[48:63], v[128:131], a[224:227], v[48:63]
    v_add_f32 v250, v250, v5
    v_cvt_pk_bf16_f32 v180, v4, v5
    v_exp_f32 v7, v27
    v_add_f32 v250, v250, v6
    v_exp_f32 v4, v28
    v_add_f32 v250, v250, v7
    v_cvt_pk_bf16_f32 v181, v6, v7
    v_exp_f32 v5, v29
    v_mfma_f32_32x32x16_bf16 v[48:63], v[132:135], a[228:231], v[48:63]
    v_add_f32 v250, v250, v4
    v_exp_f32 v6, v30
    v_add_f32 v250, v250, v5
    v_cvt_pk_bf16_f32 v182, v4, v5
    v_exp_f32 v7, v31
    v_add_f32 v250, v250, v6
    v_add_f32 v250, v250, v7
    v_cvt_pk_bf16_f32 v183, v6, v7
    v_add_f32 v247, v247, v250
    v_mfma_f32_32x32x16_bf16 v[48:63], v[136:139], a[232:235], v[48:63]
    v_max3_f32 v8, v32, v33, v34
    v_max3_f32 v8, v8, v35, v36
    v_max3_f32 v8, v8, v37, v38
    v_max3_f32 v8, v8, v39, v40
    v_max3_f32 v8, v8, v41, v42
    v_max3_f32 v8, v8, v43, v44
    v_max3_f32 v8, v8, v45, v46
    v_max_f32 v8, v8, v47
    v_mov_b32 v9, v8
    s_nop 1
    v_permlane32_swap_b32 v8, v9
    v_mfma_f32_32x32x16_bf16 v[48:63], v[140:143], a[236:239], v[48:63]
    s_add_u32 s48, s99, 57344
    s_pack_ll_b32_b16 m0, s48, 0
    s_nop 0
    buffer_load_dwordx4 v244, s[16:19], s48 offen nt lds
    v_max_f32 v8, v8, v9
    v_sub_f32 v80, 0, v8
    v_sub_f32 v32, v32, v8
    v_sub_f32 v33, v33, v8
    v_sub_f32 v34, v34, v8
    v_sub_f32 v35, v35, v8
    v_sub_f32 v36, v36, v8
    v_sub_f32 v37, v37, v8
    v_sub_f32 v38, v38, v8
    v_mfma_f32_32x32x16_bf16 a[0:15], v[144:147], v[176:179], 0
    v_sub_f32 v39, v39, v8
    v_sub_f32 v40, v40, v8
    v_sub_f32 v41, v41, v8
    v_sub_f32 v42, v42, v8
    ds_read_b128 v[112:115], v232 offset:16384
    ds_read_b128 v[116:119], v233 offset:16384
    ds_read_b128 v[120:123], v234 offset:16384
    ds_read_b128 v[124:127], v235 offset:16384
    v_sub_f32 v43, v43, v8
    v_sub_f32 v44, v44, v8
    v_sub_f32 v45, v45, v8
    v_mfma_f32_32x32x16_bf16 a[16:31], v[148:151], v[176:179], 0
    v_sub_f32 v46, v46, v8
    v_sub_f32 v47, v47, v8
    v_mov_b32 v81, v80
    v_mov_b32 v82, v80
    v_mov_b32 v83, v80
    v_mov_b32 v84, v80
    v_mov_b32 v85, v80
    v_mov_b32 v86, v80
    v_mov_b32 v87, v80
    v_mov_b32 v88, v80
    v_mov_b32 v89, v80
    v_mfma_f32_32x32x16_bf16 a[32:47], v[152:155], v[176:179], 0
    v_mov_b32 v90, v80
    v_mov_b32 v91, v80
    v_mov_b32 v92, v80
    v_mov_b32 v93, v80
    v_mov_b32 v94, v80
    v_mov_b32 v95, v80
    v_mov_b32 v248, 0
    ds_read_b128 v[128:131], v236 offset:16384
    ds_read_b128 v[132:135], v237 offset:16384
    ds_read_b128 v[136:139], v238 offset:16384
    ds_read_b128 v[140:143], v239 offset:16384
    s_waitcnt lgkmcnt(8)
    v_mfma_f32_32x32x16_bf16 a[48:63], v[156:159], v[176:179], 0
    s_add_u32 s48, s99, 58368
    s_pack_ll_b32_b16 m0, s48, 0
    s_nop 0
    buffer_load_dwordx4 v244, s[16:19], s48 offen nt lds
    v_exp_f32 v4, v32
    v_exp_f32 v5, v33
    v_exp_f32 v6, v34
    v_add_f32 v251, v4, v5
    v_cvt_pk_bf16_f32 v184, v4, v5
    v_exp_f32 v7, v35
    v_mfma_f32_32x32x16_bf16 a[0:15], v[160:163], v[180:183], a[0:15]
    v_add_f32 v251, v251, v6
    v_exp_f32 v4, v36
    v_add_f32 v251, v251, v7
    v_cvt_pk_bf16_f32 v185, v6, v7
    v_exp_f32 v5, v37
    v_add_f32 v251, v251, v4
    v_exp_f32 v6, v38
    v_add_f32 v251, v251, v5
    v_mfma_f32_32x32x16_bf16 a[16:31], v[164:167], v[180:183], a[16:31]
    v_cvt_pk_bf16_f32 v186, v4, v5
    v_exp_f32 v7, v39
    v_add_f32 v251, v251, v6
    v_exp_f32 v4, v40
    v_add_f32 v251, v251, v7
    v_cvt_pk_bf16_f32 v187, v6, v7
    v_exp_f32 v5, v41
    v_add_f32 v251, v251, v4
    v_mfma_f32_32x32x16_bf16 a[32:47], v[168:171], v[180:183], a[32:47]
    v_exp_f32 v6, v42
    v_add_f32 v251, v251, v5
    v_cvt_pk_bf16_f32 v188, v4, v5
    v_exp_f32 v7, v43
    v_add_f32 v251, v251, v6
    v_exp_f32 v4, v44
    v_add_f32 v251, v251, v7
    v_cvt_pk_bf16_f32 v189, v6, v7
    v_mfma_f32_32x32x16_bf16 a[48:63], v[172:175], v[180:183], a[48:63]
    v_exp_f32 v5, v45
    v_add_f32 v251, v251, v4
    v_exp_f32 v6, v46
    v_add_f32 v251, v251, v5
    v_cvt_pk_bf16_f32 v190, v4, v5
    v_exp_f32 v7, v47
    v_add_f32 v251, v251, v6
    v_add_f32 v251, v251, v7
    v_cvt_pk_bf16_f32 v191, v6, v7
    v_add_f32 v248, v248, v251
    v_max3_f32 v8, v48, v49, v50
    v_max3_f32 v8, v8, v51, v52
    v_max3_f32 v8, v8, v53, v54
    v_max3_f32 v8, v8, v55, v56
    v_max3_f32 v8, v8, v57, v58
    v_max3_f32 v8, v8, v59, v60
    v_max3_f32 v8, v8, v61, v62
    v_max_f32 v8, v8, v63
    v_mov_b32 v9, v8
    s_nop 1
    v_permlane32_swap_b32 v8, v9
    v_max_f32 v8, v8, v9
    v_sub_f32 v96, 0, v8
    v_sub_f32 v48, v48, v8
    v_sub_f32 v49, v49, v8
    v_sub_f32 v50, v50, v8
    v_sub_f32 v51, v51, v8
    v_sub_f32 v52, v52, v8
    v_sub_f32 v53, v53, v8
    v_sub_f32 v54, v54, v8
    v_sub_f32 v55, v55, v8
    v_sub_f32 v56, v56, v8
    v_sub_f32 v57, v57, v8
    v_sub_f32 v58, v58, v8
    v_sub_f32 v59, v59, v8
    v_sub_f32 v60, v60, v8
    v_sub_f32 v61, v61, v8
    v_sub_f32 v62, v62, v8
    v_sub_f32 v63, v63, v8
    v_mov_b32 v97, v96
    v_mov_b32 v98, v96
    v_mov_b32 v99, v96
    v_mov_b32 v100, v96
    v_mov_b32 v101, v96
    v_mov_b32 v102, v96
    v_mov_b32 v103, v96
    v_mov_b32 v104, v96
    v_mov_b32 v105, v96
    v_mov_b32 v106, v96
    v_mov_b32 v107, v96
    v_mov_b32 v108, v96
    v_mov_b32 v109, v96
    v_mov_b32 v110, v96
    v_mov_b32 v111, v96
    v_mov_b32 v249, 0
    v_exp_f32 v4, v48
    v_exp_f32 v5, v49
    s_add_u32 s49, s99, 49152
    s_add_u32 s48, s99, 65536
    s_mov_b32 s98, 1024
    s_mov_b32 s50, 0
    s_mov_b32 s5, 0
.p2align 3
L_loop:
    s_waitcnt lgkmcnt(0)
    v_mfma_f32_32x32x16_bf16 v[16:31], v[112:115], v[200:203], v[64:79]
    v_exp_f32 v6, v50
    s_pack_ll_b32_b16 m0, s49, 1
    v_add_f32 v252, v4, v5
    v_cvt_pk_bf16_f32 v192, v4, v5
    v_mfma_f32_32x32x16_bf16 v[16:31], v[116:119], v[204:207], v[16:31]
    v_exp_f32 v7, v51
    buffer_load_dwordx4 v246, s[20:23], s49 offen nt lds
    v_mfma_f32_32x32x16_bf16 v[16:31], v[120:123], v[208:211], v[16:31]
    v_add_f32 v252, v252, v6
    s_add_u32 s49, s49, s98
    v_exp_f32 v4, v52
    v_add_f32 v252, v252, v7
    v_mfma_f32_32x32x16_bf16 v[16:31], v[124:127], v[212:215], v[16:31]
    v_cvt_pk_bf16_f32 v193, v6, v7
    v_exp_f32 v5, v53
    v_add_f32 v252, v252, v4
    v_exp_f32 v6, v54
    v_mfma_f32_32x32x16_bf16 v[16:31], v[128:131], a[192:195], v[16:31]
    v_add_f32 v252, v252, v5
    v_cvt_pk_bf16_f32 v194, v4, v5
    v_exp_f32 v7, v55
    v_add_f32 v252, v252, v6
    v_mfma_f32_32x32x16_bf16 v[16:31], v[132:135], a[196:199], v[16:31]
    v_exp_f32 v4, v56
    v_add_f32 v252, v252, v7
    v_cvt_pk_bf16_f32 v195, v6, v7
    v_exp_f32 v5, v57
    v_mfma_f32_32x32x16_bf16 v[16:31], v[136:139], a[200:203], v[16:31]
    v_add_f32 v252, v252, v4
    s_pack_ll_b32_b16 m0, s48, 0
    v_exp_f32 v6, v58
    v_add_f32 v252, v252, v5
    v_mfma_f32_32x32x16_bf16 v[16:31], v[140:143], a[204:207], v[16:31]
    v_cvt_pk_bf16_f32 v196, v4, v5
    buffer_load_dwordx4 v244, s[16:19], s48 offen nt lds
    v_mfma_f32_32x32x16_bf16 a[64:79], v[144:147], v[184:187], a[64:79]
    v_exp_f32 v7, v59
    s_add_u32 s48, s48, s98
    s_xor_b32 s98, s98, 6144
    v_add_f32 v252, v252, v6
    v_exp_f32 v4, v60
    v_mfma_f32_32x32x16_bf16 a[80:95], v[148:151], v[184:187], a[80:95]
    v_add_f32 v252, v252, v7
    v_cvt_pk_bf16_f32 v197, v6, v7
    v_exp_f32 v5, v61
    v_add_f32 v252, v252, v4
    v_mfma_f32_32x32x16_bf16 a[96:111], v[152:155], v[184:187], a[96:111]
    v_exp_f32 v6, v62
    v_add_f32 v252, v252, v5
    v_cvt_pk_bf16_f32 v198, v4, v5
    v_mfma_f32_32x32x16_bf16 a[112:127], v[156:159], v[184:187], a[112:127]
    v_exp_f32 v7, v63
    v_add_f32 v252, v252, v6
    v_add_f32 v252, v252, v7
    v_cvt_pk_bf16_f32 v199, v6, v7
    v_exp_f32 v4, v16
    v_mfma_f32_32x32x16_bf16 a[64:79], v[160:163], v[188:191], a[64:79]
    v_cmp_lt_f32 vcc, s51, v252
    s_pack_ll_b32_b16 m0, s49, 1
    v_exp_f32 v5, v17
    v_mfma_f32_32x32x16_bf16 a[80:95], v[164:167], v[188:191], a[80:95]
    s_cbranch_vccnz L_tr0
L_back0:
    buffer_load_dwordx4 v246, s[20:23], s49 offen nt lds
    v_add_f32 v249, v249, v252
    v_mfma_f32_32x32x16_bf16 a[96:111], v[168:171], v[188:191], a[96:111]
    v_exp_f32 v6, v18
    s_add_u32 s49, s49, s98
    v_add_f32 v250, v4, v5
    v_cvt_pk_bf16_f32 v176, v4, v5
    v_mfma_f32_32x32x16_bf16 a[112:127], v[172:175], v[188:191], a[112:127]
    v_exp_f32 v7, v19
    v_add_f32 v250, v250, v6
    v_exp_f32 v4, v20
    v_add_f32 v250, v250, v7
    v_mfma_f32_32x32x16_bf16 v[32:47], v[112:115], v[216:219], v[80:95]
    v_cvt_pk_bf16_f32 v177, v6, v7
    v_exp_f32 v5, v21
    v_add_f32 v250, v250, v4
    v_exp_f32 v6, v22
    v_mfma_f32_32x32x16_bf16 v[32:47], v[116:119], v[220:223], v[32:47]
    v_add_f32 v250, v250, v5
    v_cvt_pk_bf16_f32 v178, v4, v5
    v_exp_f32 v7, v23
    v_add_f32 v250, v250, v6
    v_mfma_f32_32x32x16_bf16 v[32:47], v[120:123], v[224:227], v[32:47]
    v_exp_f32 v4, v24
    v_add_f32 v250, v250, v7
    v_cvt_pk_bf16_f32 v179, v6, v7
    v_exp_f32 v5, v25
    v_mfma_f32_32x32x16_bf16 v[32:47], v[124:127], v[228:231], v[32:47]
    v_add_f32 v250, v250, v4
    s_pack_ll_b32_b16 m0, s48, 0
    v_exp_f32 v6, v26
    v_add_f32 v250, v250, v5
    v_mfma_f32_32x32x16_bf16 v[32:47], v[128:131], a[208:211], v[32:47]
    v_cvt_pk_bf16_f32 v180, v4, v5
    buffer_load_dwordx4 v244, s[16:19], s48 offen nt lds
    v_mfma_f32_32x32x16_bf16 v[32:47], v[132:135], a[212:215], v[32:47]
    v_exp_f32 v7, v27
    s_add_u32 s48, s48, s98
    s_xor_b32 s98, s98, 6144
    v_add_f32 v250, v250, v6
    v_mfma_f32_32x32x16_bf16 v[32:47], v[136:139], a[216:219], v[32:47]
    v_exp_f32 v4, v28
    v_add_f32 v250, v250, v7
    v_cvt_pk_bf16_f32 v181, v6, v7
    v_exp_f32 v5, v29
    v_mfma_f32_32x32x16_bf16 v[32:47], v[140:143], a[220:223], v[32:47]
    v_add_f32 v250, v250, v4
    v_exp_f32 v6, v30
    v_add_f32 v250, v250, v5
    v_cvt_pk_bf16_f32 v182, v4, v5
    v_mfma_f32_32x32x16_bf16 a[128:143], v[144:147], v[192:195], a[128:143]
    s_waitcnt vmcnt(4)
    s_cmp_lg_u32 s50, 0
    s_cbranch_scc1 L_w1
    s_waitcnt vmcnt(3)
L_w1:
    s_barrier
    v_exp_f32 v7, v31
    v_mfma_f32_32x32x16_bf16 a[144:159], v[148:151], v[192:195], a[144:159]
    v_add_f32 v250, v250, v6
    ds_read_b64_tr_b16 v[144:145], v240 offset:16384
    s_pack_ll_b32_b16 m0, s49, 1
    v_add_f32 v250, v250, v7
    v_cvt_pk_bf16_f32 v183, v6, v7
    v_mfma_f32_32x32x16_bf16 a[160:175], v[152:155], v[192:195], a[160:175]
    ds_read_b64_tr_b16 v[146:147], v240 offset:18432
    buffer_load_dwordx4 v246, s[20:23], s49 offen nt lds
    v_mfma_f32_32x32x16_bf16 a[176:191], v[156:159], v[192:195], a[176:191]
    v_exp_f32 v4, v32
    s_add_u32 s49, s49, s98
    ds_read_b64_tr_b16 v[148:149], v241 offset:16384
    v_cmp_lt_f32 vcc, s51, v250
    v_mfma_f32_32x32x16_bf16 a[128:143], v[160:163], v[196:199], a[128:143]
    v_exp_f32 v5, v33
    ds_read_b64_tr_b16 v[150:151], v241 offset:18432
    s_cbranch_vccnz L_tr1
L_back1:
    v_add_f32 v247, v247, v250
    v_exp_f32 v6, v34
    v_mfma_f32_32x32x16_bf16 a[144:159], v[164:167], v[196:199], a[144:159]
    v_add_f32 v251, v4, v5
    ds_read_b64_tr_b16 v[152:153], v242 offset:16384
    v_cvt_pk_bf16_f32 v184, v4, v5
    v_exp_f32 v7, v35
    v_mfma_f32_32x32x16_bf16 a[160:175], v[168:171], v[196:199], a[160:175]
    v_add_f32 v251, v251, v6
    ds_read_b64_tr_b16 v[154:155], v242 offset:18432
    v_exp_f32 v4, v36
    v_add_f32 v251, v251, v7
    v_mfma_f32_32x32x16_bf16 a[176:191], v[172:175], v[196:199], a[176:191]
    v_cvt_pk_bf16_f32 v185, v6, v7
    ds_read_b64_tr_b16 v[156:157], v243 offset:16384
    v_exp_f32 v5, v37
    v_add_f32 v251, v251, v4
    v_mfma_f32_32x32x16_bf16 v[48:63], v[112:115], a[240:243], v[96:111]
    v_exp_f32 v6, v38
    ds_read_b64_tr_b16 v[158:159], v243 offset:18432
    s_pack_ll_b32_b16 m0, s48, 0
    v_add_f32 v251, v251, v5
    v_cvt_pk_bf16_f32 v186, v4, v5
    v_mfma_f32_32x32x16_bf16 v[48:63], v[116:119], a[244:247], v[48:63]
    ds_read_b64_tr_b16 v[160:161], v240 offset:20480
    buffer_load_dwordx4 v244, s[16:19], s48 offen nt lds
    v_mfma_f32_32x32x16_bf16 v[48:63], v[120:123], a[248:251], v[48:63]
    v_exp_f32 v7, v39
    s_add_u32 s48, s48, s98
    s_xor_b32 s98, s98, 6144
    ds_read_b64_tr_b16 v[162:163], v240 offset:22528
    v_add_f32 v251, v251, v6
    v_mfma_f32_32x32x16_bf16 v[48:63], v[124:127], a[252:255], v[48:63]
    v_exp_f32 v4, v40
    ds_read_b64_tr_b16 v[164:165], v241 offset:20480
    v_add_f32 v251, v251, v7
    v_cvt_pk_bf16_f32 v187, v6, v7
    v_mfma_f32_32x32x16_bf16 v[48:63], v[128:131], a[224:227], v[48:63]
    v_exp_f32 v5, v41
    ds_read_b64_tr_b16 v[166:167], v241 offset:22528
    v_add_f32 v251, v251, v4
    v_exp_f32 v6, v42
    v_mfma_f32_32x32x16_bf16 v[48:63], v[132:135], a[228:231], v[48:63]
    v_add_f32 v251, v251, v5
    ds_read_b64_tr_b16 v[168:169], v242 offset:20480
    v_cvt_pk_bf16_f32 v188, v4, v5
    v_exp_f32 v7, v43
    v_mfma_f32_32x32x16_bf16 v[48:63], v[136:139], a[232:235], v[48:63]
    v_add_f32 v251, v251, v6
    ds_read_b64_tr_b16 v[170:171], v242 offset:22528
    s_pack_ll_b32_b16 m0, s49, 1
    v_exp_f32 v4, v44
    v_add_f32 v251, v251, v7
    v_mfma_f32_32x32x16_bf16 v[48:63], v[140:143], a[236:239], v[48:63]
    ds_read_b64_tr_b16 v[172:173], v243 offset:20480
    buffer_load_dwordx4 v246, s[20:23], s49 offen nt lds
    s_waitcnt lgkmcnt(4)
    v_mfma_f32_32x32x16_bf16 a[0:15], v[144:147], v[176:179], a[0:15]
    v_cvt_pk_bf16_f32 v189, v6, v7
    s_add_u32 s49, s49, s98
    ds_read_b64_tr_b16 v[174:175], v243 offset:22528
    v_exp_f32 v5, v45
    v_add_f32 v251, v251, v4
    v_mfma_f32_32x32x16_bf16 a[16:31], v[148:151], v[176:179], a[16:31]
    v_exp_f32 v6, v46
    ds_read_b128 v[112:115], v232 offset:32768
    ds_read_b128 v[116:119], v233 offset:32768
    v_add_f32 v251, v251, v5
    v_mfma_f32_32x32x16_bf16 a[32:47], v[152:155], v[176:179], a[32:47]
    v_cvt_pk_bf16_f32 v190, v4, v5
    ds_read_b128 v[120:123], v234 offset:32768
    v_exp_f32 v7, v47
    v_add_f32 v251, v251, v6
    v_add_f32 v251, v251, v7
    v_mfma_f32_32x32x16_bf16 a[48:63], v[156:159], v[176:179], a[48:63]
    v_cvt_pk_bf16_f32 v191, v6, v7
    ds_read_b128 v[124:127], v235 offset:32768
    v_exp_f32 v4, v48
    v_cmp_lt_f32 vcc, s51, v251
    v_mfma_f32_32x32x16_bf16 a[0:15], v[160:163], v[180:183], a[0:15]
    v_exp_f32 v5, v49
    ds_read_b128 v[128:131], v236 offset:32768
    s_pack_ll_b32_b16 m0, s48, 0
    s_cbranch_vccnz L_tr2
L_back2:
    v_add_f32 v248, v248, v251
    s_waitcnt lgkmcnt(5)
    v_mfma_f32_32x32x16_bf16 a[16:31], v[164:167], v[180:183], a[16:31]
    ds_read_b128 v[132:135], v237 offset:32768
    buffer_load_dwordx4 v244, s[16:19], s48 offen nt lds
    v_mfma_f32_32x32x16_bf16 a[32:47], v[168:171], v[180:183], a[32:47]
    s_add_u32 s48, s48, s98
    s_xor_b32 s98, s98, 6144
    ds_read_b128 v[136:139], v238 offset:32768
    v_mfma_f32_32x32x16_bf16 a[48:63], v[172:175], v[180:183], a[48:63]
    ds_read_b128 v[140:143], v239 offset:32768
    s_waitcnt lgkmcnt(4)
    v_mfma_f32_32x32x16_bf16 v[16:31], v[112:115], v[200:203], v[64:79]
    v_exp_f32 v6, v50
    v_add_f32 v252, v4, v5
    v_cvt_pk_bf16_f32 v192, v4, v5
    v_exp_f32 v7, v51
    v_mfma_f32_32x32x16_bf16 v[16:31], v[116:119], v[204:207], v[16:31]
    v_add_f32 v252, v252, v6
    v_exp_f32 v4, v52
    v_add_f32 v252, v252, v7
    v_cvt_pk_bf16_f32 v193, v6, v7
    v_mfma_f32_32x32x16_bf16 v[16:31], v[120:123], v[208:211], v[16:31]
    v_exp_f32 v5, v53
    v_add_f32 v252, v252, v4
    v_exp_f32 v6, v54
    v_mfma_f32_32x32x16_bf16 v[16:31], v[124:127], v[212:215], v[16:31]
    v_add_f32 v252, v252, v5
    s_pack_ll_b32_b16 m0, s49, 1
    v_cvt_pk_bf16_f32 v194, v4, v5
    v_exp_f32 v7, v55
    s_waitcnt lgkmcnt(0)
    v_mfma_f32_32x32x16_bf16 v[16:31], v[128:131], a[192:195], v[16:31]
    v_add_f32 v252, v252, v6
    buffer_load_dwordx4 v246, s[20:23], s49 offen nt lds
    v_mfma_f32_32x32x16_bf16 v[16:31], v[132:135], a[196:199], v[16:31]
    v_exp_f32 v4, v56
    s_add_u32 s49, s49, s98
    v_add_f32 v252, v252, v7
    v_cvt_pk_bf16_f32 v195, v6, v7
    v_mfma_f32_32x32x16_bf16 v[16:31], v[136:139], a[200:203], v[16:31]
    v_exp_f32 v5, v57
    v_add_f32 v252, v252, v4
    v_exp_f32 v6, v58
    v_add_f32 v252, v252, v5
    v_mfma_f32_32x32x16_bf16 v[16:31], v[140:143], a[204:207], v[16:31]
    v_cvt_pk_bf16_f32 v196, v4, v5
    v_exp_f32 v7, v59
    v_add_f32 v252, v252, v6
    v_exp_f32 v4, v60
    v_mfma_f32_32x32x16_bf16 a[64:79], v[144:147], v[184:187], a[64:79]
    v_add_f32 v252, v252, v7
    v_cvt_pk_bf16_f32 v197, v6, v7
    v_exp_f32 v5, v61
    v_add_f32 v252, v252, v4
    v_mfma_f32_32x32x16_bf16 a[80:95], v[148:151], v[184:187], a[80:95]
    v_exp_f32 v6, v62
    s_pack_ll_b32_b16 m0, s48, 0
    v_add_f32 v252, v252, v5
    v_cvt_pk_bf16_f32 v198, v4, v5
    v_mfma_f32_32x32x16_bf16 a[96:111], v[152:155], v[184:187], a[96:111]
    v_exp_f32 v7, v63
    buffer_load_dwordx4 v244, s[16:19], s48 offen nt lds
    v_mfma_f32_32x32x16_bf16 a[112:127], v[156:159], v[184:187], a[112:127]
    v_add_f32 v252, v252, v6
    s_add_u32 s48, s48, s98
    s_xor_b32 s98, s98, 6144
    v_add_f32 v252, v252, v7
    v_cvt_pk_bf16_f32 v199, v6, v7
    v_mfma_f32_32x32x16_bf16 a[64:79], v[160:163], v[188:191], a[64:79]
    v_exp_f32 v4, v16
    v_cmp_lt_f32 vcc, s51, v252
    v_exp_f32 v5, v17
    v_mfma_f32_32x32x16_bf16 a[80:95], v[164:167], v[188:191], a[80:95]
    s_cbranch_vccnz L_tr3
L_back3:
    v_add_f32 v249, v249, v252
    v_exp_f32 v6, v18
    v_add_f32 v250, v4, v5
    v_mfma_f32_32x32x16_bf16 a[96:111], v[168:171], v[188:191], a[96:111]
    v_cvt_pk_bf16_f32 v176, v4, v5
    v_exp_f32 v7, v19
    v_add_f32 v250, v250, v6
    v_exp_f32 v4, v20
    v_mfma_f32_32x32x16_bf16 a[112:127], v[172:175], v[188:191], a[112:127]
    v_add_f32 v250, v250, v7
    v_cvt_pk_bf16_f32 v177, v6, v7
    v_exp_f32 v5, v21
    v_add_f32 v250, v250, v4
    v_mfma_f32_32x32x16_bf16 v[32:47], v[112:115], v[216:219], v[80:95]
    v_exp_f32 v6, v22
    s_pack_ll_b32_b16 m0, s49, 1
    v_add_f32 v250, v250, v5
    v_cvt_pk_bf16_f32 v178, v4, v5
    v_mfma_f32_32x32x16_bf16 v[32:47], v[116:119], v[220:223], v[32:47]
    v_exp_f32 v7, v23
    buffer_load_dwordx4 v246, s[20:23], s49 offen nt lds
    v_mfma_f32_32x32x16_bf16 v[32:47], v[120:123], v[224:227], v[32:47]
    v_add_f32 v250, v250, v6
    s_add_u32 s49, s49, s98
    v_exp_f32 v4, v24
    v_add_f32 v250, v250, v7
    v_mfma_f32_32x32x16_bf16 v[32:47], v[124:127], v[228:231], v[32:47]
    v_cvt_pk_bf16_f32 v179, v6, v7
    v_exp_f32 v5, v25
    v_add_f32 v250, v250, v4
    v_exp_f32 v6, v26
    v_mfma_f32_32x32x16_bf16 v[32:47], v[128:131], a[208:211], v[32:47]
    v_add_f32 v250, v250, v5
    v_cvt_pk_bf16_f32 v180, v4, v5
    v_exp_f32 v7, v27
    v_mfma_f32_32x32x16_bf16 v[32:47], v[132:135], a[212:215], v[32:47]
    v_add_f32 v250, v250, v6
    v_exp_f32 v4, v28
    v_add_f32 v250, v250, v7
    v_cvt_pk_bf16_f32 v181, v6, v7
    v_mfma_f32_32x32x16_bf16 v[32:47], v[136:139], a[216:219], v[32:47]
    v_exp_f32 v5, v29
    s_pack_ll_b32_b16 m0, s48, 0
    v_add_f32 v250, v250, v4
    v_exp_f32 v6, v30
    v_mfma_f32_32x32x16_bf16 v[32:47], v[140:143], a[220:223], v[32:47]
    v_add_f32 v250, v250, v5
    buffer_load_dwordx4 v244, s[16:19], s48 offen nt lds
    v_mfma_f32_32x32x16_bf16 a[128:143], v[144:147], v[192:195], a[128:143]
    s_add_u32 s48, s48, s98
    s_xor_b32 s98, s98, 6144
    s_waitcnt vmcnt(4)
    s_cmp_lg_u32 s50, 0
    s_cbranch_scc1 L_w2
    s_waitcnt vmcnt(3)
L_w2:
    s_barrier
    v_mfma_f32_32x32x16_bf16 a[144:159], v[148:151], v[192:195], a[144:159]
    v_cvt_pk_bf16_f32 v182, v4, v5
    ds_read_b64_tr_b16 v[144:145], v240 offset:32768
    v_exp_f32 v7, v31
    v_mfma_f32_32x32x16_bf16 a[160:175], v[152:155], v[192:195], a[160:175]
    v_add_f32 v250, v250, v6
    ds_read_b64_tr_b16 v[146:147], v240 offset:34816
    v_add_f32 v250, v250, v7
    v_cvt_pk_bf16_f32 v183, v6, v7
    v_mfma_f32_32x32x16_bf16 a[176:191], v[156:159], v[192:195], a[176:191]
    v_exp_f32 v4, v32
    ds_read_b64_tr_b16 v[148:149], v241 offset:32768
    v_cmp_lt_f32 vcc, s51, v250
    v_exp_f32 v5, v33
    v_mfma_f32_32x32x16_bf16 a[128:143], v[160:163], v[196:199], a[128:143]
    s_cbranch_vccnz L_tr4
L_back4:
    ds_read_b64_tr_b16 v[150:151], v241 offset:34816
    s_pack_ll_b32_b16 m0, s49, 1
    v_add_f32 v247, v247, v250
    v_mfma_f32_32x32x16_bf16 a[144:159], v[164:167], v[196:199], a[144:159]
    v_exp_f32 v6, v34
    ds_read_b64_tr_b16 v[152:153], v242 offset:32768
    buffer_load_dwordx4 v246, s[20:23], s49 offen nt lds
    v_mfma_f32_32x32x16_bf16 a[160:175], v[168:171], v[196:199], a[160:175]
    v_add_f32 v251, v4, v5
    s_add_u32 s49, s49, s98
    ds_read_b64_tr_b16 v[154:155], v242 offset:34816
    v_cvt_pk_bf16_f32 v184, v4, v5
    v_mfma_f32_32x32x16_bf16 a[176:191], v[172:175], v[196:199], a[176:191]
    v_exp_f32 v7, v35
    ds_read_b64_tr_b16 v[156:157], v243 offset:32768
    v_add_f32 v251, v251, v6
    v_exp_f32 v4, v36
    v_mfma_f32_32x32x16_bf16 v[48:63], v[112:115], a[240:243], v[96:111]
    v_add_f32 v251, v251, v7
    ds_read_b64_tr_b16 v[158:159], v243 offset:34816
    v_cvt_pk_bf16_f32 v185, v6, v7
    v_exp_f32 v5, v37
    v_mfma_f32_32x32x16_bf16 v[48:63], v[116:119], a[244:247], v[48:63]
    v_add_f32 v251, v251, v4
    ds_read_b64_tr_b16 v[160:161], v240 offset:36864
    v_exp_f32 v6, v38
    v_add_f32 v251, v251, v5
    v_cvt_pk_bf16_f32 v186, v4, v5
    v_mfma_f32_32x32x16_bf16 v[48:63], v[120:123], a[248:251], v[48:63]
    v_exp_f32 v7, v39
    ds_read_b64_tr_b16 v[162:163], v240 offset:38912
    v_add_f32 v251, v251, v6
    v_mfma_f32_32x32x16_bf16 v[48:63], v[124:127], a[252:255], v[48:63]
    v_exp_f32 v4, v40
    ds_read_b64_tr_b16 v[164:165], v241 offset:36864
    s_pack_ll_b32_b16 m0, s48, 0
    v_add_f32 v251, v251, v7
    v_cvt_pk_bf16_f32 v187, v6, v7
    v_mfma_f32_32x32x16_bf16 v[48:63], v[128:131], a[224:227], v[48:63]
    ds_read_b64_tr_b16 v[166:167], v241 offset:38912
    buffer_load_dwordx4 v244, s[16:19], s48 offen nt lds
    v_mfma_f32_32x32x16_bf16 v[48:63], v[132:135], a[228:231], v[48:63]
    v_exp_f32 v5, v41
    s_add_u32 s48, s48, s98
    s_xor_b32 s98, s98, 6144
    ds_read_b64_tr_b16 v[168:169], v242 offset:36864
    v_add_f32 v251, v251, v4
    v_mfma_f32_32x32x16_bf16 v[48:63], v[136:139], a[232:235], v[48:63]
    v_exp_f32 v6, v42
    ds_read_b64_tr_b16 v[170:171], v242 offset:38912
    v_add_f32 v251, v251, v5
    v_cvt_pk_bf16_f32 v188, v4, v5
    v_mfma_f32_32x32x16_bf16 v[48:63], v[140:143], a[236:239], v[48:63]
    v_exp_f32 v7, v43
    ds_read_b64_tr_b16 v[172:173], v243 offset:36864
    v_add_f32 v251, v251, v6
    v_exp_f32 v4, v44
    s_waitcnt lgkmcnt(4)
    v_mfma_f32_32x32x16_bf16 a[0:15], v[144:147], v[176:179], a[0:15]
    v_add_f32 v251, v251, v7
    ds_read_b64_tr_b16 v[174:175], v243 offset:38912
    v_cvt_pk_bf16_f32 v189, v6, v7
    v_exp_f32 v5, v45
    v_mfma_f32_32x32x16_bf16 a[16:31], v[148:151], v[176:179], a[16:31]
    v_add_f32 v251, v251, v4
    ds_read_b128 v[112:115], v232 offset:49152
    ds_read_b128 v[116:119], v233 offset:49152
    s_pack_ll_b32_b16 m0, s49, 1
    v_exp_f32 v6, v46
    v_mfma_f32_32x32x16_bf16 a[32:47], v[152:155], v[176:179], a[32:47]
    ds_read_b128 v[120:123], v234 offset:49152
    buffer_load_dwordx4 v246, s[20:23], s49 offen nt lds
    v_mfma_f32_32x32x16_bf16 a[48:63], v[156:159], v[176:179], a[48:63]
    v_add_f32 v251, v251, v5
    s_add_u32 s49, s49, s98
    ds_read_b128 v[124:127], v235 offset:49152
    v_cvt_pk_bf16_f32 v190, v4, v5
    v_mfma_f32_32x32x16_bf16 a[0:15], v[160:163], v[180:183], a[0:15]
    v_exp_f32 v7, v47
    ds_read_b128 v[128:131], v236 offset:49152
    v_add_f32 v251, v251, v6
    v_add_f32 v251, v251, v7
    v_cvt_pk_bf16_f32 v191, v6, v7
    s_waitcnt lgkmcnt(5)
    v_mfma_f32_32x32x16_bf16 a[16:31], v[164:167], v[180:183], a[16:31]
    v_exp_f32 v4, v48
    ds_read_b128 v[132:135], v237 offset:49152
    v_cmp_lt_f32 vcc, s51, v251
    v_exp_f32 v5, v49
    v_mfma_f32_32x32x16_bf16 a[32:47], v[168:171], v[180:183], a[32:47]
    s_cbranch_vccnz L_tr5
L_back5:
    ds_read_b128 v[136:139], v238 offset:49152
    v_add_f32 v248, v248, v251
    v_mfma_f32_32x32x16_bf16 a[48:63], v[172:175], v[180:183], a[48:63]
    ds_read_b128 v[140:143], v239 offset:49152
    s_waitcnt lgkmcnt(4)
    v_mfma_f32_32x32x16_bf16 v[16:31], v[112:115], v[200:203], v[64:79]
    v_exp_f32 v6, v50
    s_pack_ll_b32_b16 m0, s48, 0
    v_add_f32 v252, v4, v5
    v_cvt_pk_bf16_f32 v192, v4, v5
    v_mfma_f32_32x32x16_bf16 v[16:31], v[116:119], v[204:207], v[16:31]
    v_exp_f32 v7, v51
    buffer_load_dwordx4 v244, s[16:19], s48 offen nt lds
    v_mfma_f32_32x32x16_bf16 v[16:31], v[120:123], v[208:211], v[16:31]
    v_add_f32 v252, v252, v6
    s_add_u32 s48, s48, s98
    s_xor_b32 s98, s98, 6144
    v_exp_f32 v4, v52
    v_add_f32 v252, v252, v7
    v_mfma_f32_32x32x16_bf16 v[16:31], v[124:127], v[212:215], v[16:31]
    v_cvt_pk_bf16_f32 v193, v6, v7
    v_exp_f32 v5, v53
    v_add_f32 v252, v252, v4
    s_waitcnt lgkmcnt(0)
    v_mfma_f32_32x32x16_bf16 v[16:31], v[128:131], a[192:195], v[16:31]
    v_exp_f32 v6, v54
    v_add_f32 v252, v252, v5
    v_cvt_pk_bf16_f32 v194, v4, v5
    v_exp_f32 v7, v55
    v_mfma_f32_32x32x16_bf16 v[16:31], v[132:135], a[196:199], v[16:31]
    v_add_f32 v252, v252, v6
    v_exp_f32 v4, v56
    v_add_f32 v252, v252, v7
    v_cvt_pk_bf16_f32 v195, v6, v7
    v_mfma_f32_32x32x16_bf16 v[16:31], v[136:139], a[200:203], v[16:31]
    v_exp_f32 v5, v57
    s_pack_ll_b32_b16 m0, s49, 1
    v_add_f32 v252, v252, v4
    v_exp_f32 v6, v58
    v_mfma_f32_32x32x16_bf16 v[16:31], v[140:143], a[204:207], v[16:31]
    v_add_f32 v252, v252, v5
    buffer_load_dwordx4 v246, s[20:23], s49 offen nt lds
    v_cvt_pk_bf16_f32 v196, v4, v5
    v_mfma_f32_32x32x16_bf16 a[64:79], v[144:147], v[184:187], a[64:79]
    v_exp_f32 v7, v59
    s_add_u32 s49, s49, s98
    v_add_f32 v252, v252, v6
    v_exp_f32 v4, v60
    v_mfma_f32_32x32x16_bf16 a[80:95], v[148:151], v[184:187], a[80:95]
    v_add_f32 v252, v252, v7
    v_cvt_pk_bf16_f32 v197, v6, v7
    v_exp_f32 v5, v61
    v_add_f32 v252, v252, v4
    v_mfma_f32_32x32x16_bf16 a[96:111], v[152:155], v[184:187], a[96:111]
    v_exp_f32 v6, v62
    v_add_f32 v252, v252, v5
    v_cvt_pk_bf16_f32 v198, v4, v5
    v_mfma_f32_32x32x16_bf16 a[112:127], v[156:159], v[184:187], a[112:127]
    v_exp_f32 v7, v63
    v_add_f32 v252, v252, v6
    v_add_f32 v252, v252, v7
    v_cvt_pk_bf16_f32 v199, v6, v7
    v_exp_f32 v4, v16
    v_mfma_f32_32x32x16_bf16 a[64:79], v[160:163], v[188:191], a[64:79]
    v_cmp_lt_f32 vcc, s51, v252
    s_pack_ll_b32_b16 m0, s48, 0
    v_exp_f32 v5, v17
    v_mfma_f32_32x32x16_bf16 a[80:95], v[164:167], v[188:191], a[80:95]
    s_cbranch_vccnz L_tr6
L_back6:
    buffer_load_dwordx4 v244, s[16:19], s48 offen nt lds
    v_add_f32 v249, v249, v252
    v_mfma_f32_32x32x16_bf16 a[96:111], v[168:171], v[188:191], a[96:111]
    v_exp_f32 v6, v18
    s_add_u32 s48, s48, s98
    s_xor_b32 s98, s98, 6144
    v_add_f32 v250, v4, v5
    v_cvt_pk_bf16_f32 v176, v4, v5
    v_mfma_f32_32x32x16_bf16 a[112:127], v[172:175], v[188:191], a[112:127]
    v_exp_f32 v7, v19
    v_add_f32 v250, v250, v6
    v_exp_f32 v4, v20
    v_mfma_f32_32x32x16_bf16 v[32:47], v[112:115], v[216:219], v[80:95]
    v_add_f32 v250, v250, v7
    v_cvt_pk_bf16_f32 v177, v6, v7
    v_exp_f32 v5, v21
    v_add_f32 v250, v250, v4
    v_mfma_f32_32x32x16_bf16 v[32:47], v[116:119], v[220:223], v[32:47]
    v_exp_f32 v6, v22
    v_add_f32 v250, v250, v5
    v_cvt_pk_bf16_f32 v178, v4, v5
    v_exp_f32 v7, v23
    v_mfma_f32_32x32x16_bf16 v[32:47], v[120:123], v[224:227], v[32:47]
    v_add_f32 v250, v250, v6
    v_exp_f32 v4, v24
    v_add_f32 v250, v250, v7
    v_cvt_pk_bf16_f32 v179, v6, v7
    v_mfma_f32_32x32x16_bf16 v[32:47], v[124:127], v[228:231], v[32:47]
    v_exp_f32 v5, v25
    s_pack_ll_b32_b16 m0, s49, 1
    v_add_f32 v250, v250, v4
    v_exp_f32 v6, v26
    v_mfma_f32_32x32x16_bf16 v[32:47], v[128:131], a[208:211], v[32:47]
    v_add_f32 v250, v250, v5
    buffer_load_dwordx4 v246, s[20:23], s49 offen nt lds
    v_mfma_f32_32x32x16_bf16 v[32:47], v[132:135], a[212:215], v[32:47]
    v_cvt_pk_bf16_f32 v180, v4, v5
    s_add_u32 s49, s49, s98
    v_exp_f32 v7, v27
    v_add_f32 v250, v250, v6
    v_mfma_f32_32x32x16_bf16 v[32:47], v[136:139], a[216:219], v[32:47]
    v_exp_f32 v4, v28
    v_add_f32 v250, v250, v7
    v_cvt_pk_bf16_f32 v181, v6, v7
    v_exp_f32 v5, v29
    v_mfma_f32_32x32x16_bf16 v[32:47], v[140:143], a[220:223], v[32:47]
    v_add_f32 v250, v250, v4
    v_exp_f32 v6, v30
    v_add_f32 v250, v250, v5
    v_cvt_pk_bf16_f32 v182, v4, v5
    v_mfma_f32_32x32x16_bf16 a[128:143], v[144:147], v[192:195], a[128:143]
    s_waitcnt vmcnt(4)
    s_cmp_lg_u32 s50, 0
    s_cbranch_scc1 L_w3
    s_waitcnt vmcnt(3)
L_w3:
    s_barrier
    v_exp_f32 v7, v31
    v_mfma_f32_32x32x16_bf16 a[144:159], v[148:151], v[192:195], a[144:159]
    v_add_f32 v250, v250, v6
    ds_read_b64_tr_b16 v[144:145], v240 offset:49152
    s_pack_ll_b32_b16 m0, s48, 0
    v_add_f32 v250, v250, v7
    v_cvt_pk_bf16_f32 v183, v6, v7
    v_mfma_f32_32x32x16_bf16 a[160:175], v[152:155], v[192:195], a[160:175]
    ds_read_b64_tr_b16 v[146:147], v240 offset:51200
    buffer_load_dwordx4 v244, s[16:19], s48 offen nt lds
    v_mfma_f32_32x32x16_bf16 a[176:191], v[156:159], v[192:195], a[176:191]
    v_exp_f32 v4, v32
    s_add_u32 s48, s48, s98
    s_xor_b32 s98, s98, 6144
    ds_read_b64_tr_b16 v[148:149], v241 offset:49152
    v_cmp_lt_f32 vcc, s51, v250
    v_mfma_f32_32x32x16_bf16 a[128:143], v[160:163], v[196:199], a[128:143]
    v_exp_f32 v5, v33
    ds_read_b64_tr_b16 v[150:151], v241 offset:51200
    s_cbranch_vccnz L_tr7
L_back7:
    v_add_f32 v247, v247, v250
    v_mfma_f32_32x32x16_bf16 a[144:159], v[164:167], v[196:199], a[144:159]
    v_exp_f32 v6, v34
    ds_read_b64_tr_b16 v[152:153], v242 offset:49152
    v_add_f32 v251, v4, v5
    v_cvt_pk_bf16_f32 v184, v4, v5
    v_mfma_f32_32x32x16_bf16 a[160:175], v[168:171], v[196:199], a[160:175]
    v_exp_f32 v7, v35
    ds_read_b64_tr_b16 v[154:155], v242 offset:51200
    v_add_f32 v251, v251, v6
    v_exp_f32 v4, v36
    v_mfma_f32_32x32x16_bf16 a[176:191], v[172:175], v[196:199], a[176:191]
    v_add_f32 v251, v251, v7
    ds_read_b64_tr_b16 v[156:157], v243 offset:49152
    v_cvt_pk_bf16_f32 v185, v6, v7
    v_exp_f32 v5, v37
    v_add_f32 v251, v251, v4
    v_mfma_f32_32x32x16_bf16 v[48:63], v[112:115], a[240:243], v[96:111]
    v_exp_f32 v6, v38
    ds_read_b64_tr_b16 v[158:159], v243 offset:51200
    s_pack_ll_b32_b16 m0, s49, 1
    v_add_f32 v251, v251, v5
    v_mfma_f32_32x32x16_bf16 v[48:63], v[116:119], a[244:247], v[48:63]
    v_cvt_pk_bf16_f32 v186, v4, v5
    ds_read_b64_tr_b16 v[160:161], v240 offset:53248
    buffer_load_dwordx4 v246, s[20:23], s49 offen nt lds
    v_mfma_f32_32x32x16_bf16 v[48:63], v[120:123], a[248:251], v[48:63]
    v_exp_f32 v7, v39
    s_add_u32 s49, s49, s98
    ds_read_b64_tr_b16 v[162:163], v240 offset:55296
    v_add_f32 v251, v251, v6
    v_mfma_f32_32x32x16_bf16 v[48:63], v[124:127], a[252:255], v[48:63]
    v_exp_f32 v4, v40
    ds_read_b64_tr_b16 v[164:165], v241 offset:53248
    v_add_f32 v251, v251, v7
    v_cvt_pk_bf16_f32 v187, v6, v7
    v_mfma_f32_32x32x16_bf16 v[48:63], v[128:131], a[224:227], v[48:63]
    v_exp_f32 v5, v41
    ds_read_b64_tr_b16 v[166:167], v241 offset:55296
    v_add_f32 v251, v251, v4
    v_exp_f32 v6, v42
    v_mfma_f32_32x32x16_bf16 v[48:63], v[132:135], a[228:231], v[48:63]
    v_add_f32 v251, v251, v5
    ds_read_b64_tr_b16 v[168:169], v242 offset:53248
    v_cvt_pk_bf16_f32 v188, v4, v5
    v_exp_f32 v7, v43
    v_mfma_f32_32x32x16_bf16 v[48:63], v[136:139], a[232:235], v[48:63]
    v_add_f32 v251, v251, v6
    ds_read_b64_tr_b16 v[170:171], v242 offset:55296
    s_pack_ll_b32_b16 m0, s48, 0
    v_exp_f32 v4, v44
    v_add_f32 v251, v251, v7
    v_mfma_f32_32x32x16_bf16 v[48:63], v[140:143], a[236:239], v[48:63]
    ds_read_b64_tr_b16 v[172:173], v243 offset:53248
    buffer_load_dwordx4 v244, s[16:19], s48 offen nt lds
    s_waitcnt lgkmcnt(4)
    v_mfma_f32_32x32x16_bf16 a[0:15], v[144:147], v[176:179], a[0:15]
    v_cvt_pk_bf16_f32 v189, v6, v7
    s_add_u32 s48, s48, s98
    s_xor_b32 s98, s98, 6144
    ds_read_b64_tr_b16 v[174:175], v243 offset:55296
    v_exp_f32 v5, v45
    v_mfma_f32_32x32x16_bf16 a[16:31], v[148:151], v[176:179], a[16:31]
    v_add_f32 v251, v251, v4
    ds_read_b128 v[112:115], v232 offset:0
    ds_read_b128 v[116:119], v233 offset:0
    v_exp_f32 v6, v46
    v_add_f32 v251, v251, v5
    v_mfma_f32_32x32x16_bf16 a[32:47], v[152:155], v[176:179], a[32:47]
    v_cvt_pk_bf16_f32 v190, v4, v5
    ds_read_b128 v[120:123], v234 offset:0
    v_exp_f32 v7, v47
    v_add_f32 v251, v251, v6
    v_mfma_f32_32x32x16_bf16 a[48:63], v[156:159], v[176:179], a[48:63]
    v_add_f32 v251, v251, v7
    ds_read_b128 v[124:127], v235 offset:0
    v_cvt_pk_bf16_f32 v191, v6, v7
    v_exp_f32 v4, v48
    v_mfma_f32_32x32x16_bf16 a[0:15], v[160:163], v[180:183], a[0:15]
    v_cmp_lt_f32 vcc, s51, v251
    ds_read_b128 v[128:131], v236 offset:0
    s_pack_ll_b32_b16 m0, s49, 1
    v_exp_f32 v5, v49
    s_waitcnt lgkmcnt(5)
    v_mfma_f32_32x32x16_bf16 a[16:31], v[164:167], v[180:183], a[16:31]
    s_cbranch_vccnz L_tr8
L_back8:
    ds_read_b128 v[132:135], v237 offset:0
    buffer_load_dwordx4 v246, s[20:23], s49 offen nt lds
    v_mfma_f32_32x32x16_bf16 a[32:47], v[168:171], v[180:183], a[32:47]
    v_add_f32 v248, v248, v251
    s_add_u32 s49, s49, s98
    ds_read_b128 v[136:139], v238 offset:0
    v_mfma_f32_32x32x16_bf16 a[48:63], v[172:175], v[180:183], a[48:63]
    ds_read_b128 v[140:143], v239 offset:0
    s_waitcnt lgkmcnt(4)
    v_mfma_f32_32x32x16_bf16 v[16:31], v[112:115], v[200:203], v[64:79]
    v_exp_f32 v6, v50
    v_add_f32 v252, v4, v5
    v_cvt_pk_bf16_f32 v192, v4, v5
    v_exp_f32 v7, v51
    v_mfma_f32_32x32x16_bf16 v[16:31], v[116:119], v[204:207], v[16:31]
    v_add_f32 v252, v252, v6
    v_exp_f32 v4, v52
    v_add_f32 v252, v252, v7
    v_cvt_pk_bf16_f32 v193, v6, v7
    v_mfma_f32_32x32x16_bf16 v[16:31], v[120:123], v[208:211], v[16:31]
    v_exp_f32 v5, v53
    v_add_f32 v252, v252, v4
    v_exp_f32 v6, v54
    v_mfma_f32_32x32x16_bf16 v[16:31], v[124:127], v[212:215], v[16:31]
    v_add_f32 v252, v252, v5
    s_pack_ll_b32_b16 m0, s48, 0
    v_cvt_pk_bf16_f32 v194, v4, v5
    v_exp_f32 v7, v55
    s_waitcnt lgkmcnt(0)
    v_mfma_f32_32x32x16_bf16 v[16:31], v[128:131], a[192:195], v[16:31]
    v_add_f32 v252, v252, v6
    buffer_load_dwordx4 v244, s[16:19], s48 offen nt lds
    v_mfma_f32_32x32x16_bf16 v[16:31], v[132:135], a[196:199], v[16:31]
    v_exp_f32 v4, v56
    s_add_u32 s48, s48, s98
    s_xor_b32 s98, s98, 6144
    v_add_f32 v252, v252, v7
    v_cvt_pk_bf16_f32 v195, v6, v7
    v_mfma_f32_32x32x16_bf16 v[16:31], v[136:139], a[200:203], v[16:31]
    v_exp_f32 v5, v57
    v_add_f32 v252, v252, v4
    v_exp_f32 v6, v58
    v_mfma_f32_32x32x16_bf16 v[16:31], v[140:143], a[204:207], v[16:31]
    v_add_f32 v252, v252, v5
    v_cvt_pk_bf16_f32 v196, v4, v5
    v_exp_f32 v7, v59
    v_add_f32 v252, v252, v6
    v_mfma_f32_32x32x16_bf16 a[64:79], v[144:147], v[184:187], a[64:79]
    v_exp_f32 v4, v60
    v_add_f32 v252, v252, v7
    v_cvt_pk_bf16_f32 v197, v6, v7
    v_exp_f32 v5, v61
    v_mfma_f32_32x32x16_bf16 a[80:95], v[148:151], v[184:187], a[80:95]
    v_add_f32 v252, v252, v4
    s_pack_ll_b32_b16 m0, s49, 1
    v_exp_f32 v6, v62
    v_add_f32 v252, v252, v5
    v_mfma_f32_32x32x16_bf16 a[96:111], v[152:155], v[184:187], a[96:111]
    v_cvt_pk_bf16_f32 v198, v4, v5
    buffer_load_dwordx4 v246, s[20:23], s49 offen nt lds
    v_mfma_f32_32x32x16_bf16 a[112:127], v[156:159], v[184:187], a[112:127]
    v_exp_f32 v7, v63
    s_add_u32 s49, s49, s98
    v_add_f32 v252, v252, v6
    v_add_f32 v252, v252, v7
    v_cvt_pk_bf16_f32 v199, v6, v7
    v_mfma_f32_32x32x16_bf16 a[64:79], v[160:163], v[188:191], a[64:79]
    v_exp_f32 v4, v16
    v_cmp_lt_f32 vcc, s51, v252
    v_exp_f32 v5, v17
    v_mfma_f32_32x32x16_bf16 a[80:95], v[164:167], v[188:191], a[80:95]
    s_cbranch_vccnz L_tr9
L_back9:
    v_add_f32 v249, v249, v252
    v_exp_f32 v6, v18
    v_add_f32 v250, v4, v5
    v_mfma_f32_32x32x16_bf16 a[96:111], v[168:171], v[188:191], a[96:111]
    v_cvt_pk_bf16_f32 v176, v4, v5
    v_exp_f32 v7, v19
    v_add_f32 v250, v250, v6
    v_exp_f32 v4, v20
    v_mfma_f32_32x32x16_bf16 a[112:127], v[172:175], v[188:191], a[112:127]
    v_add_f32 v250, v250, v7
    v_cvt_pk_bf16_f32 v177, v6, v7
    v_exp_f32 v5, v21
    v_add_f32 v250, v250, v4
    v_mfma_f32_32x32x16_bf16 v[32:47], v[112:115], v[216:219], v[80:95]
    v_exp_f32 v6, v22
    s_pack_ll_b32_b16 m0, s48, 0
    v_add_f32 v250, v250, v5
    v_cvt_pk_bf16_f32 v178, v4, v5
    v_mfma_f32_32x32x16_bf16 v[32:47], v[116:119], v[220:223], v[32:47]
    v_exp_f32 v7, v23
    buffer_load_dwordx4 v244, s[16:19], s48 offen nt lds
    v_mfma_f32_32x32x16_bf16 v[32:47], v[120:123], v[224:227], v[32:47]
    v_add_f32 v250, v250, v6
    s_add_u32 s48, s48, s98
    s_xor_b32 s98, s98, 6144
    v_exp_f32 v4, v24
    v_mfma_f32_32x32x16_bf16 v[32:47], v[124:127], v[228:231], v[32:47]
    v_add_f32 v250, v250, v7
    v_cvt_pk_bf16_f32 v179, v6, v7
    v_exp_f32 v5, v25
    v_add_f32 v250, v250, v4
    v_mfma_f32_32x32x16_bf16 v[32:47], v[128:131], a[208:211], v[32:47]
    v_exp_f32 v6, v26
    v_add_f32 v250, v250, v5
    v_cvt_pk_bf16_f32 v180, v4, v5
    v_exp_f32 v7, v27
    v_mfma_f32_32x32x16_bf16 v[32:47], v[132:135], a[212:215], v[32:47]
    v_add_f32 v250, v250, v6
    v_exp_f32 v4, v28
    v_add_f32 v250, v250, v7
    v_cvt_pk_bf16_f32 v181, v6, v7
    v_mfma_f32_32x32x16_bf16 v[32:47], v[136:139], a[216:219], v[32:47]
    v_exp_f32 v5, v29
    s_pack_ll_b32_b16 m0, s49, 1
    v_add_f32 v250, v250, v4
    v_exp_f32 v6, v30
    v_mfma_f32_32x32x16_bf16 v[32:47], v[140:143], a[220:223], v[32:47]
    v_add_f32 v250, v250, v5
    buffer_load_dwordx4 v246, s[20:23], s49 offen nt lds
    v_mfma_f32_32x32x16_bf16 a[128:143], v[144:147], v[192:195], a[128:143]
    s_add_u32 s49, s49, s98
    s_waitcnt vmcnt(4)
    s_cmp_lg_u32 s50, 0
    s_cbranch_scc1 L_w4
    s_waitcnt vmcnt(3)
L_w4:
    s_barrier
    v_mfma_f32_32x32x16_bf16 a[144:159], v[148:151], v[192:195], a[144:159]
    v_cvt_pk_bf16_f32 v182, v4, v5
    ds_read_b64_tr_b16 v[144:145], v240 offset:0
    v_exp_f32 v7, v31
    v_add_f32 v250, v250, v6
    v_mfma_f32_32x32x16_bf16 a[160:175], v[152:155], v[192:195], a[160:175]
    v_add_f32 v250, v250, v7
    ds_read_b64_tr_b16 v[146:147], v240 offset:2048
    v_cvt_pk_bf16_f32 v183, v6, v7
    v_mfma_f32_32x32x16_bf16 a[176:191], v[156:159], v[192:195], a[176:191]
    v_exp_f32 v4, v32
    ds_read_b64_tr_b16 v[148:149], v241 offset:0
    v_cmp_lt_f32 vcc, s51, v250
    v_exp_f32 v5, v33
    v_mfma_f32_32x32x16_bf16 a[128:143], v[160:163], v[196:199], a[128:143]
    s_cbranch_vccnz L_tr10
L_back10:
    ds_read_b64_tr_b16 v[150:151], v241 offset:2048
    s_pack_ll_b32_b16 m0, s48, 0
    v_add_f32 v247, v247, v250
    v_mfma_f32_32x32x16_bf16 a[144:159], v[164:167], v[196:199], a[144:159]
    v_exp_f32 v6, v34
    ds_read_b64_tr_b16 v[152:153], v242 offset:0
    buffer_load_dwordx4 v244, s[16:19], s48 offen nt lds
    v_mfma_f32_32x32x16_bf16 a[160:175], v[168:171], v[196:199], a[160:175]
    v_add_f32 v251, v4, v5
    s_add_u32 s48, s48, s98
    s_xor_b32 s98, s98, 6144
    ds_read_b64_tr_b16 v[154:155], v242 offset:2048
    v_cvt_pk_bf16_f32 v184, v4, v5
    v_mfma_f32_32x32x16_bf16 a[176:191], v[172:175], v[196:199], a[176:191]
    v_exp_f32 v7, v35
    ds_read_b64_tr_b16 v[156:157], v243 offset:0
    v_add_f32 v251, v251, v6
    v_exp_f32 v4, v36
    v_mfma_f32_32x32x16_bf16 v[48:63], v[112:115], a[240:243], v[96:111]
    v_add_f32 v251, v251, v7
    ds_read_b64_tr_b16 v[158:159], v243 offset:2048
    v_cvt_pk_bf16_f32 v185, v6, v7
    v_exp_f32 v5, v37
    v_mfma_f32_32x32x16_bf16 v[48:63], v[116:119], a[244:247], v[48:63]
    v_add_f32 v251, v251, v4
    ds_read_b64_tr_b16 v[160:161], v240 offset:4096
    v_exp_f32 v6, v38
    v_add_f32 v251, v251, v5
    v_mfma_f32_32x32x16_bf16 v[48:63], v[120:123], a[248:251], v[48:63]
    v_cvt_pk_bf16_f32 v186, v4, v5
    ds_read_b64_tr_b16 v[162:163], v240 offset:6144
    v_exp_f32 v7, v39
    v_add_f32 v251, v251, v6
    v_mfma_f32_32x32x16_bf16 v[48:63], v[124:127], a[252:255], v[48:63]
    v_exp_f32 v4, v40
    ds_read_b64_tr_b16 v[164:165], v241 offset:4096
    s_pack_ll_b32_b16 m0, s49, 1
    v_add_f32 v251, v251, v7
    v_mfma_f32_32x32x16_bf16 v[48:63], v[128:131], a[224:227], v[48:63]
    v_cvt_pk_bf16_f32 v187, v6, v7
    ds_read_b64_tr_b16 v[166:167], v241 offset:6144
    buffer_load_dwordx4 v246, s[20:23], s49 offen nt lds
    v_mfma_f32_32x32x16_bf16 v[48:63], v[132:135], a[228:231], v[48:63]
    v_exp_f32 v5, v41
    s_add_u32 s49, s49, s98
    ds_read_b64_tr_b16 v[168:169], v242 offset:4096
    v_add_f32 v251, v251, v4
    v_mfma_f32_32x32x16_bf16 v[48:63], v[136:139], a[232:235], v[48:63]
    v_exp_f32 v6, v42
    ds_read_b64_tr_b16 v[170:171], v242 offset:6144
    v_add_f32 v251, v251, v5
    v_cvt_pk_bf16_f32 v188, v4, v5
    v_mfma_f32_32x32x16_bf16 v[48:63], v[140:143], a[236:239], v[48:63]
    v_exp_f32 v7, v43
    ds_read_b64_tr_b16 v[172:173], v243 offset:4096
    v_add_f32 v251, v251, v6
    v_exp_f32 v4, v44
    s_waitcnt lgkmcnt(4)
    v_mfma_f32_32x32x16_bf16 a[0:15], v[144:147], v[176:179], a[0:15]
    v_add_f32 v251, v251, v7
    ds_read_b64_tr_b16 v[174:175], v243 offset:6144
    v_cvt_pk_bf16_f32 v189, v6, v7
    v_exp_f32 v5, v45
    v_mfma_f32_32x32x16_bf16 a[16:31], v[148:151], v[176:179], a[16:31]
    v_add_f32 v251, v251, v4
    ds_read_b128 v[112:115], v232 offset:16384
    ds_read_b128 v[116:119], v233 offset:16384
    s_pack_ll_b32_b16 m0, s48, 0
    v_exp_f32 v6, v46
    v_mfma_f32_32x32x16_bf16 a[32:47], v[152:155], v[176:179], a[32:47]
    ds_read_b128 v[120:123], v234 offset:16384
    buffer_load_dwordx4 v244, s[16:19], s48 offen nt lds
    v_mfma_f32_32x32x16_bf16 a[48:63], v[156:159], v[176:179], a[48:63]
    v_add_f32 v251, v251, v5
    s_add_u32 s48, s48, s98
    s_xor_b32 s98, s98, 6144
    ds_read_b128 v[124:127], v235 offset:16384
    v_cvt_pk_bf16_f32 v190, v4, v5
    v_mfma_f32_32x32x16_bf16 a[0:15], v[160:163], v[180:183], a[0:15]
    v_exp_f32 v7, v47
    ds_read_b128 v[128:131], v236 offset:16384
    v_add_f32 v251, v251, v6
    v_add_f32 v251, v251, v7
    v_cvt_pk_bf16_f32 v191, v6, v7
    s_waitcnt lgkmcnt(5)
    v_mfma_f32_32x32x16_bf16 a[16:31], v[164:167], v[180:183], a[16:31]
    v_exp_f32 v4, v48
    ds_read_b128 v[132:135], v237 offset:16384
    v_cmp_lt_f32 vcc, s51, v251
    v_mfma_f32_32x32x16_bf16 a[32:47], v[168:171], v[180:183], a[32:47]
    v_exp_f32 v5, v49
    ds_read_b128 v[136:139], v238 offset:16384
    s_cbranch_vccnz L_tr11
L_back11:
    v_add_f32 v248, v248, v251
    v_mfma_f32_32x32x16_bf16 a[48:63], v[172:175], v[180:183], a[48:63]
    ds_read_b128 v[140:143], v239 offset:16384
    s_add_u32 s50, s50, 1
    s_cmp_lt_u32 s50, 3
    s_cbranch_scc1 L_loop
    s_waitcnt lgkmcnt(4)
    v_mfma_f32_32x32x16_bf16 v[16:31], v[112:115], v[200:203], v[64:79]
    v_exp_f32 v6, v50
    s_pack_ll_b32_b16 m0, s49, 1
    v_add_f32 v252, v4, v5
    v_cvt_pk_bf16_f32 v192, v4, v5
    v_mfma_f32_32x32x16_bf16 v[16:31], v[116:119], v[204:207], v[16:31]
    v_exp_f32 v7, v51
    buffer_load_dwordx4 v246, s[20:23], s49 offen nt lds
    v_mfma_f32_32x32x16_bf16 v[16:31], v[120:123], v[208:211], v[16:31]
    v_add_f32 v252, v252, v6
    s_add_u32 s49, s49, s98
    v_exp_f32 v4, v52
    v_add_f32 v252, v252, v7
    v_mfma_f32_32x32x16_bf16 v[16:31], v[124:127], v[212:215], v[16:31]
    v_cvt_pk_bf16_f32 v193, v6, v7
    v_exp_f32 v5, v53
    v_add_f32 v252, v252, v4
    v_exp_f32 v6, v54
    s_waitcnt lgkmcnt(0)
    v_mfma_f32_32x32x16_bf16 v[16:31], v[128:131], a[192:195], v[16:31]
    v_add_f32 v252, v252, v5
    v_cvt_pk_bf16_f32 v194, v4, v5
    v_exp_f32 v7, v55
    v_add_f32 v252, v252, v6
    v_mfma_f32_32x32x16_bf16 v[16:31], v[132:135], a[196:199], v[16:31]
    v_exp_f32 v4, v56
    v_add_f32 v252, v252, v7
    v_cvt_pk_bf16_f32 v195, v6, v7
    v_exp_f32 v5, v57
    v_mfma_f32_32x32x16_bf16 v[16:31], v[136:139], a[200:203], v[16:31]
    v_add_f32 v252, v252, v4
    s_pack_ll_b32_b16 m0, s48, 0
    v_exp_f32 v6, v58
    v_add_f32 v252, v252, v5
    v_mfma_f32_32x32x16_bf16 v[16:31], v[140:143], a[204:207], v[16:31]
    v_cvt_pk_bf16_f32 v196, v4, v5
    buffer_load_dwordx4 v244, s[16:19], s48 offen nt lds
    v_mfma_f32_32x32x16_bf16 a[64:79], v[144:147], v[184:187], a[64:79]
    v_exp_f32 v7, v59
    s_add_u32 s48, s48, s98
    s_xor_b32 s98, s98, 6144
    v_add_f32 v252, v252, v6
    v_mfma_f32_32x32x16_bf16 a[80:95], v[148:151], v[184:187], a[80:95]
    v_exp_f32 v4, v60
    v_add_f32 v252, v252, v7
    v_cvt_pk_bf16_f32 v197, v6, v7
    v_exp_f32 v5, v61
    v_mfma_f32_32x32x16_bf16 a[96:111], v[152:155], v[184:187], a[96:111]
    v_add_f32 v252, v252, v4
    v_exp_f32 v6, v62
    v_add_f32 v252, v252, v5
    v_cvt_pk_bf16_f32 v198, v4, v5
    v_mfma_f32_32x32x16_bf16 a[112:127], v[156:159], v[184:187], a[112:127]
    v_exp_f32 v7, v63
    v_add_f32 v252, v252, v6
    v_add_f32 v252, v252, v7
    v_cvt_pk_bf16_f32 v199, v6, v7
    v_mfma_f32_32x32x16_bf16 a[64:79], v[160:163], v[188:191], a[64:79]
    v_exp_f32 v4, v16
    s_pack_ll_b32_b16 m0, s49, 1
    v_cmp_lt_f32 vcc, s51, v252
    v_exp_f32 v5, v17
    v_mfma_f32_32x32x16_bf16 a[80:95], v[164:167], v[188:191], a[80:95]
    s_cbranch_vccnz L_tr12
L_back12:
    buffer_load_dwordx4 v246, s[20:23], s49 offen nt lds
    v_add_f32 v249, v249, v252
    v_mfma_f32_32x32x16_bf16 a[96:111], v[168:171], v[188:191], a[96:111]
    v_exp_f32 v6, v18
    s_add_u32 s49, s49, s98
    v_add_f32 v250, v4, v5
    v_cvt_pk_bf16_f32 v176, v4, v5
    v_mfma_f32_32x32x16_bf16 a[112:127], v[172:175], v[188:191], a[112:127]
    v_exp_f32 v7, v19
    v_add_f32 v250, v250, v6
    v_exp_f32 v4, v20
    v_add_f32 v250, v250, v7
    v_mfma_f32_32x32x16_bf16 v[32:47], v[112:115], v[216:219], v[80:95]
    v_cvt_pk_bf16_f32 v177, v6, v7
    v_exp_f32 v5, v21
    v_add_f32 v250, v250, v4
    v_mfma_f32_32x32x16_bf16 v[32:47], v[116:119], v[220:223], v[32:47]
    v_exp_f32 v6, v22
    v_add_f32 v250, v250, v5
    v_cvt_pk_bf16_f32 v178, v4, v5
    v_exp_f32 v7, v23
    v_mfma_f32_32x32x16_bf16 v[32:47], v[120:123], v[224:227], v[32:47]
    v_add_f32 v250, v250, v6
    s_pack_ll_b32_b16 m0, s48, 0
    v_exp_f32 v4, v24
    v_add_f32 v250, v250, v7
    v_cvt_pk_bf16_f32 v179, v6, v7
    v_mfma_f32_32x32x16_bf16 v[32:47], v[124:127], v[228:231], v[32:47]
    v_exp_f32 v5, v25
    buffer_load_dwordx4 v244, s[16:19], s48 offen nt lds
    v_mfma_f32_32x32x16_bf16 v[32:47], v[128:131], a[208:211], v[32:47]
    v_add_f32 v250, v250, v4
    s_add_u32 s48, s48, s98
    s_xor_b32 s98, s98, 6144
    v_exp_f32 v6, v26
    v_mfma_f32_32x32x16_bf16 v[32:47], v[132:135], a[212:215], v[32:47]
    v_add_f32 v250, v250, v5
    v_cvt_pk_bf16_f32 v180, v4, v5
    v_exp_f32 v7, v27
    v_add_f32 v250, v250, v6
    v_mfma_f32_32x32x16_bf16 v[32:47], v[136:139], a[216:219], v[32:47]
    v_exp_f32 v4, v28
    v_add_f32 v250, v250, v7
    v_cvt_pk_bf16_f32 v181, v6, v7
    v_exp_f32 v5, v29
    v_mfma_f32_32x32x16_bf16 v[32:47], v[140:143], a[220:223], v[32:47]
    v_add_f32 v250, v250, v4
    v_exp_f32 v6, v30
    v_add_f32 v250, v250, v5
    v_cvt_pk_bf16_f32 v182, v4, v5
    v_mfma_f32_32x32x16_bf16 a[128:143], v[144:147], v[192:195], a[128:143]
    s_waitcnt vmcnt(3)
    s_barrier
    s_pack_ll_b32_b16 m0, s49, 1
    v_exp_f32 v7, v31
    v_mfma_f32_32x32x16_bf16 a[144:159], v[148:151], v[192:195], a[144:159]
    v_add_f32 v250, v250, v6
    ds_read_b64_tr_b16 v[144:145], v240 offset:16384
    buffer_load_dwordx4 v246, s[20:23], s49 offen nt lds
    v_mfma_f32_32x32x16_bf16 a[160:175], v[152:155], v[192:195], a[160:175]
    v_add_f32 v250, v250, v7
    s_add_u32 s49, s49, s98
    ds_read_b64_tr_b16 v[146:147], v240 offset:18432
    v_cvt_pk_bf16_f32 v183, v6, v7
    v_mfma_f32_32x32x16_bf16 a[176:191], v[156:159], v[192:195], a[176:191]
    v_exp_f32 v4, v32
    ds_read_b64_tr_b16 v[148:149], v241 offset:16384
    v_cmp_lt_f32 vcc, s51, v250
    v_exp_f32 v5, v33
    v_mfma_f32_32x32x16_bf16 a[128:143], v[160:163], v[196:199], a[128:143]
    s_cbranch_vccnz L_tr13
L_back13:
    ds_read_b64_tr_b16 v[150:151], v241 offset:18432
    v_add_f32 v247, v247, v250
    v_exp_f32 v6, v34
    v_mfma_f32_32x32x16_bf16 a[144:159], v[164:167], v[196:199], a[144:159]
    v_add_f32 v251, v4, v5
    ds_read_b64_tr_b16 v[152:153], v242 offset:16384
    v_cvt_pk_bf16_f32 v184, v4, v5
    v_exp_f32 v7, v35
    v_mfma_f32_32x32x16_bf16 a[160:175], v[168:171], v[196:199], a[160:175]
    v_add_f32 v251, v251, v6
    ds_read_b64_tr_b16 v[154:155], v242 offset:18432
    s_pack_ll_b32_b16 m0, s48, 0
    v_exp_f32 v4, v36
    v_add_f32 v251, v251, v7
    v_mfma_f32_32x32x16_bf16 a[176:191], v[172:175], v[196:199], a[176:191]
    ds_read_b64_tr_b16 v[156:157], v243 offset:16384
    buffer_load_dwordx4 v244, s[16:19], s48 offen nt lds
    v_mfma_f32_32x32x16_bf16 v[48:63], v[112:115], a[240:243], v[96:111]
    v_cvt_pk_bf16_f32 v185, v6, v7
    s_add_u32 s48, s48, s98
    s_xor_b32 s98, s98, 6144
    ds_read_b64_tr_b16 v[158:159], v243 offset:18432
    v_exp_f32 v5, v37
    v_mfma_f32_32x32x16_bf16 v[48:63], v[116:119], a[244:247], v[48:63]
    v_add_f32 v251, v251, v4
    ds_read_b64_tr_b16 v[160:161], v240 offset:20480
    v_exp_f32 v6, v38
    v_add_f32 v251, v251, v5
    v_mfma_f32_32x32x16_bf16 v[48:63], v[120:123], a[248:251], v[48:63]
    v_cvt_pk_bf16_f32 v186, v4, v5
    ds_read_b64_tr_b16 v[162:163], v240 offset:22528
    v_exp_f32 v7, v39
    v_add_f32 v251, v251, v6
    v_mfma_f32_32x32x16_bf16 v[48:63], v[124:127], a[252:255], v[48:63]
    v_exp_f32 v4, v40
    ds_read_b64_tr_b16 v[164:165], v241 offset:20480
    v_add_f32 v251, v251, v7
    v_cvt_pk_bf16_f32 v187, v6, v7
    v_exp_f32 v5, v41
    v_mfma_f32_32x32x16_bf16 v[48:63], v[128:131], a[224:227], v[48:63]
    v_add_f32 v251, v251, v4
    ds_read_b64_tr_b16 v[166:167], v241 offset:22528
    s_pack_ll_b32_b16 m0, s49, 1
    v_exp_f32 v6, v42
    v_mfma_f32_32x32x16_bf16 v[48:63], v[132:135], a[228:231], v[48:63]
    ds_read_b64_tr_b16 v[168:169], v242 offset:20480
    buffer_load_dwordx4 v246, s[20:23], s49 offen nt lds
    v_mfma_f32_32x32x16_bf16 v[48:63], v[136:139], a[232:235], v[48:63]
    v_add_f32 v251, v251, v5
    s_add_u32 s49, s49, s98
    s_xor_b32 s98, s98, 6144
    ds_read_b64_tr_b16 v[170:171], v242 offset:22528
    v_cvt_pk_bf16_f32 v188, v4, v5
    v_mfma_f32_32x32x16_bf16 v[48:63], v[140:143], a[236:239], v[48:63]
    v_exp_f32 v7, v43
    ds_read_b64_tr_b16 v[172:173], v243 offset:20480
    v_add_f32 v251, v251, v6
    v_exp_f32 v4, v44
    s_waitcnt lgkmcnt(4)
    v_mfma_f32_32x32x16_bf16 a[0:15], v[144:147], v[176:179], a[0:15]
    v_add_f32 v251, v251, v7
    ds_read_b64_tr_b16 v[174:175], v243 offset:22528
    v_cvt_pk_bf16_f32 v189, v6, v7
    v_exp_f32 v5, v45
    v_mfma_f32_32x32x16_bf16 a[16:31], v[148:151], v[176:179], a[16:31]
    v_add_f32 v251, v251, v4
    ds_read_b128 v[112:115], v232 offset:32768
    ds_read_b128 v[116:119], v233 offset:32768
    v_exp_f32 v6, v46
    v_add_f32 v251, v251, v5
    v_mfma_f32_32x32x16_bf16 a[32:47], v[152:155], v[176:179], a[32:47]
    v_cvt_pk_bf16_f32 v190, v4, v5
    ds_read_b128 v[120:123], v234 offset:32768
    s_pack_ll_b32_b16 m0, s49, 1
    v_exp_f32 v7, v47
    v_mfma_f32_32x32x16_bf16 a[48:63], v[156:159], v[176:179], a[48:63]
    v_add_f32 v251, v251, v6
    ds_read_b128 v[124:127], v235 offset:32768
    buffer_load_dwordx4 v246, s[20:23], s49 offen nt lds
    v_mfma_f32_32x32x16_bf16 a[0:15], v[160:163], v[180:183], a[0:15]
    v_add_f32 v251, v251, v7
    s_add_u32 s49, s49, s98
    s_xor_b32 s98, s98, 6144
    ds_read_b128 v[128:131], v236 offset:32768
    v_cvt_pk_bf16_f32 v191, v6, v7
    s_waitcnt lgkmcnt(5)
    v_mfma_f32_32x32x16_bf16 a[16:31], v[164:167], v[180:183], a[16:31]
    v_exp_f32 v4, v48
    ds_read_b128 v[132:135], v237 offset:32768
    v_cmp_lt_f32 vcc, s51, v251
    v_exp_f32 v5, v49
    v_mfma_f32_32x32x16_bf16 a[32:47], v[168:171], v[180:183], a[32:47]
    s_cbranch_vccnz L_tr14
L_back14:
    ds_read_b128 v[136:139], v238 offset:32768
    v_add_f32 v248, v248, v251
    v_mfma_f32_32x32x16_bf16 a[48:63], v[172:175], v[180:183], a[48:63]
    ds_read_b128 v[140:143], v239 offset:32768
    s_waitcnt lgkmcnt(4)
    v_mfma_f32_32x32x16_bf16 v[16:31], v[112:115], v[200:203], v[64:79]
    v_exp_f32 v6, v50
    s_pack_ll_b32_b16 m0, s49, 1
    v_add_f32 v252, v4, v5
    v_cvt_pk_bf16_f32 v192, v4, v5
    v_mfma_f32_32x32x16_bf16 v[16:31], v[116:119], v[204:207], v[16:31]
    buffer_load_dwordx4 v246, s[20:23], s49 offen nt lds
    v_mfma_f32_32x32x16_bf16 v[16:31], v[120:123], v[208:211], v[16:31]
    v_exp_f32 v7, v51
    s_add_u32 s49, s49, s98
    s_xor_b32 s98, s98, 6144
    v_add_f32 v252, v252, v6
    v_mfma_f32_32x32x16_bf16 v[16:31], v[124:127], v[212:215], v[16:31]
    v_exp_f32 v4, v52
    v_add_f32 v252, v252, v7
    v_cvt_pk_bf16_f32 v193, v6, v7
    v_exp_f32 v5, v53
    s_waitcnt lgkmcnt(0)
    v_mfma_f32_32x32x16_bf16 v[16:31], v[128:131], a[192:195], v[16:31]
    v_add_f32 v252, v252, v4
    v_exp_f32 v6, v54
    v_add_f32 v252, v252, v5
    v_cvt_pk_bf16_f32 v194, v4, v5
    v_mfma_f32_32x32x16_bf16 v[16:31], v[132:135], a[196:199], v[16:31]
    v_exp_f32 v7, v55
    v_add_f32 v252, v252, v6
    v_exp_f32 v4, v56
    v_mfma_f32_32x32x16_bf16 v[16:31], v[136:139], a[200:203], v[16:31]
    v_add_f32 v252, v252, v7
    s_pack_ll_b32_b16 m0, s49, 1
    v_cvt_pk_bf16_f32 v195, v6, v7
    v_exp_f32 v5, v57
    v_mfma_f32_32x32x16_bf16 v[16:31], v[140:143], a[204:207], v[16:31]
    buffer_load_dwordx4 v246, s[20:23], s49 offen nt lds
    v_mfma_f32_32x32x16_bf16 a[64:79], v[144:147], v[184:187], a[64:79]
    v_add_f32 v252, v252, v4
    s_add_u32 s49, s49, s98
    s_xor_b32 s98, s98, 6144
    v_exp_f32 v6, v58
    v_mfma_f32_32x32x16_bf16 a[80:95], v[148:151], v[184:187], a[80:95]
    v_add_f32 v252, v252, v5
    v_cvt_pk_bf16_f32 v196, v4, v5
    v_exp_f32 v7, v59
    v_add_f32 v252, v252, v6
    v_mfma_f32_32x32x16_bf16 a[96:111], v[152:155], v[184:187], a[96:111]
    v_exp_f32 v4, v60
    v_add_f32 v252, v252, v7
    v_cvt_pk_bf16_f32 v197, v6, v7
    v_mfma_f32_32x32x16_bf16 a[112:127], v[156:159], v[184:187], a[112:127]
    v_exp_f32 v5, v61
    v_add_f32 v252, v252, v4
    v_exp_f32 v6, v62
    v_add_f32 v252, v252, v5
    v_mfma_f32_32x32x16_bf16 a[64:79], v[160:163], v[188:191], a[64:79]
    v_cvt_pk_bf16_f32 v198, v4, v5
    v_exp_f32 v7, v63
    v_add_f32 v252, v252, v6
    v_add_f32 v252, v252, v7
    v_mfma_f32_32x32x16_bf16 a[80:95], v[164:167], v[188:191], a[80:95]
    v_cvt_pk_bf16_f32 v199, v6, v7
    v_exp_f32 v4, v16
    v_cmp_lt_f32 vcc, s51, v252
    v_mfma_f32_32x32x16_bf16 a[96:111], v[168:171], v[188:191], a[96:111]
    v_exp_f32 v5, v17
    s_cbranch_vccnz L_tr15
L_back15:
    v_add_f32 v249, v249, v252
    v_exp_f32 v6, v18
    v_mfma_f32_32x32x16_bf16 a[112:127], v[172:175], v[188:191], a[112:127]
    v_add_f32 v250, v4, v5
    v_cvt_pk_bf16_f32 v176, v4, v5
    v_exp_f32 v7, v19
    v_mfma_f32_32x32x16_bf16 v[32:47], v[112:115], v[216:219], v[80:95]
    v_add_f32 v250, v250, v6
    v_exp_f32 v4, v20
    v_add_f32 v250, v250, v7
    v_cvt_pk_bf16_f32 v177, v6, v7
    v_mfma_f32_32x32x16_bf16 v[32:47], v[116:119], v[220:223], v[32:47]
    v_exp_f32 v5, v21
    v_add_f32 v250, v250, v4
    v_exp_f32 v6, v22
    v_mfma_f32_32x32x16_bf16 v[32:47], v[120:123], v[224:227], v[32:47]
    v_add_f32 v250, v250, v5
    v_cvt_pk_bf16_f32 v178, v4, v5
    v_exp_f32 v7, v23
    v_add_f32 v250, v250, v6
    v_mfma_f32_32x32x16_bf16 v[32:47], v[124:127], v[228:231], v[32:47]
    v_exp_f32 v4, v24
    v_add_f32 v250, v250, v7
    v_cvt_pk_bf16_f32 v179, v6, v7
    v_mfma_f32_32x32x16_bf16 v[32:47], v[128:131], a[208:211], v[32:47]
    s_mov_b32 s5, 0
    buffer_load_dword v13, v255, s[60:63], s5 offen
    v_mfma_f32_32x32x16_bf16 v[32:47], v[132:135], a[212:215], v[32:47]
    v_exp_f32 v5, v25
    v_add_f32 v250, v250, v4
    v_exp_f32 v6, v26
    v_add_f32 v250, v250, v5
    v_mfma_f32_32x32x16_bf16 v[32:47], v[136:139], a[216:219], v[32:47]
    v_cvt_pk_bf16_f32 v180, v4, v5
    v_exp_f32 v7, v27
    v_add_f32 v250, v250, v6
    v_mfma_f32_32x32x16_bf16 v[32:47], v[140:143], a[220:223], v[32:47]
    v_exp_f32 v4, v28
    v_add_f32 v250, v250, v7
    v_cvt_pk_bf16_f32 v181, v6, v7
    v_exp_f32 v5, v29
    v_mfma_f32_32x32x16_bf16 a[128:143], v[144:147], v[192:195], a[128:143]
    s_waitcnt vmcnt(2)
    s_barrier
    v_add_f32 v250, v250, v4
    v_exp_f32 v6, v30
    v_mfma_f32_32x32x16_bf16 a[144:159], v[148:151], v[192:195], a[144:159]
    v_add_f32 v250, v250, v5
    ds_read_b64_tr_b16 v[144:145], v240 offset:32768
    v_cvt_pk_bf16_f32 v182, v4, v5
    v_exp_f32 v7, v31
    v_mfma_f32_32x32x16_bf16 a[160:175], v[152:155], v[192:195], a[160:175]
    v_add_f32 v250, v250, v6
    ds_read_b64_tr_b16 v[146:147], v240 offset:34816
    v_add_f32 v250, v250, v7
    v_cvt_pk_bf16_f32 v183, v6, v7
    v_mfma_f32_32x32x16_bf16 a[176:191], v[156:159], v[192:195], a[176:191]
    v_exp_f32 v4, v32
    ds_read_b64_tr_b16 v[148:149], v241 offset:32768
    v_cmp_lt_f32 vcc, s51, v250
    v_exp_f32 v5, v33
    v_mfma_f32_32x32x16_bf16 a[128:143], v[160:163], v[196:199], a[128:143]
    s_cbranch_vccnz L_tr16
L_back16:
    ds_read_b64_tr_b16 v[150:151], v241 offset:34816
    v_add_f32 v247, v247, v250
    v_exp_f32 v6, v34
    v_mfma_f32_32x32x16_bf16 a[144:159], v[164:167], v[196:199], a[144:159]
    v_add_f32 v251, v4, v5
    ds_read_b64_tr_b16 v[152:153], v242 offset:32768
    v_cvt_pk_bf16_f32 v184, v4, v5
    v_mfma_f32_32x32x16_bf16 a[160:175], v[168:171], v[196:199], a[160:175]
    v_exp_f32 v7, v35
    ds_read_b64_tr_b16 v[154:155], v242 offset:34816
    v_add_f32 v251, v251, v6
    v_exp_f32 v4, v36
    v_mfma_f32_32x32x16_bf16 a[176:191], v[172:175], v[196:199], a[176:191]
    v_add_f32 v251, v251, v7
    ds_read_b64_tr_b16 v[156:157], v243 offset:32768
    v_cvt_pk_bf16_f32 v185, v6, v7
    v_exp_f32 v5, v37
    v_mfma_f32_32x32x16_bf16 v[48:63], v[112:115], a[240:243], v[96:111]
    v_add_f32 v251, v251, v4
    ds_read_b64_tr_b16 v[158:159], v243 offset:34816
    v_exp_f32 v6, v38
    v_add_f32 v251, v251, v5
    v_mfma_f32_32x32x16_bf16 v[48:63], v[116:119], a[244:247], v[48:63]
    ds_read_b64_tr_b16 v[160:161], v240 offset:36864
    s_mov_b32 s5, 147456
    buffer_load_dword v13, v255, s[60:63], s5 offen
    v_mfma_f32_32x32x16_bf16 v[48:63], v[120:123], a[248:251], v[48:63]
    v_cvt_pk_bf16_f32 v186, v4, v5
    ds_read_b64_tr_b16 v[162:163], v240 offset:38912
    v_exp_f32 v7, v39
    v_mfma_f32_32x32x16_bf16 v[48:63], v[124:127], a[252:255], v[48:63]
    v_add_f32 v251, v251, v6
    ds_read_b64_tr_b16 v[164:165], v241 offset:36864
    v_exp_f32 v4, v40
    v_add_f32 v251, v251, v7
    v_mfma_f32_32x32x16_bf16 v[48:63], v[128:131], a[224:227], v[48:63]
    v_cvt_pk_bf16_f32 v187, v6, v7
    ds_read_b64_tr_b16 v[166:167], v241 offset:38912
    v_exp_f32 v5, v41
    v_mfma_f32_32x32x16_bf16 v[48:63], v[132:135], a[228:231], v[48:63]
    v_add_f32 v251, v251, v4
    ds_read_b64_tr_b16 v[168:169], v242 offset:36864
    v_exp_f32 v6, v42
    v_add_f32 v251, v251, v5
    v_mfma_f32_32x32x16_bf16 v[48:63], v[136:139], a[232:235], v[48:63]
    v_cvt_pk_bf16_f32 v188, v4, v5
    ds_read_b64_tr_b16 v[170:171], v242 offset:38912
    v_exp_f32 v7, v43
    v_add_f32 v251, v251, v6
    v_mfma_f32_32x32x16_bf16 v[48:63], v[140:143], a[236:239], v[48:63]
    v_exp_f32 v4, v44
    ds_read_b64_tr_b16 v[172:173], v243 offset:36864
    v_add_f32 v251, v251, v7
    v_cvt_pk_bf16_f32 v189, v6, v7
    s_waitcnt lgkmcnt(4)
    v_mfma_f32_32x32x16_bf16 a[0:15], v[144:147], v[176:179], a[0:15]
    v_exp_f32 v5, v45
    ds_read_b64_tr_b16 v[174:175], v243 offset:38912
    v_add_f32 v251, v251, v4
    v_exp_f32 v6, v46
    v_mfma_f32_32x32x16_bf16 a[16:31], v[148:151], v[176:179], a[16:31]
    v_add_f32 v251, v251, v5
    ds_read_b128 v[112:115], v232 offset:49152
    ds_read_b128 v[116:119], v233 offset:49152
    v_cvt_pk_bf16_f32 v190, v4, v5
    v_mfma_f32_32x32x16_bf16 a[32:47], v[152:155], v[176:179], a[32:47]
    v_exp_f32 v7, v47
    ds_read_b128 v[120:123], v234 offset:49152
    v_add_f32 v251, v251, v6
    v_add_f32 v251, v251, v7
    v_mfma_f32_32x32x16_bf16 a[48:63], v[156:159], v[176:179], a[48:63]
    v_cvt_pk_bf16_f32 v191, v6, v7
    ds_read_b128 v[124:127], v235 offset:49152
    v_exp_f32 v4, v48
    v_cmp_lt_f32 vcc, s51, v251
    v_mfma_f32_32x32x16_bf16 a[0:15], v[160:163], v[180:183], a[0:15]
    v_exp_f32 v5, v49
    ds_read_b128 v[128:131], v236 offset:49152
    s_cbranch_vccnz L_tr17
L_back17:
    v_add_f32 v248, v248, v251
    s_waitcnt lgkmcnt(5)
    v_mfma_f32_32x32x16_bf16 a[16:31], v[164:167], v[180:183], a[16:31]
    ds_read_b128 v[132:135], v237 offset:49152
    v_mfma_f32_32x32x16_bf16 a[32:47], v[168:171], v[180:183], a[32:47]
    ds_read_b128 v[136:139], v238 offset:49152
    s_mov_b32 s5, 294912
    buffer_load_dword v13, v255, s[60:63], s5 offen
    v_mfma_f32_32x32x16_bf16 a[48:63], v[172:175], v[180:183], a[48:63]
    ds_read_b128 v[140:143], v239 offset:49152
    s_waitcnt lgkmcnt(4)
    v_mfma_f32_32x32x16_bf16 v[16:31], v[112:115], v[200:203], v[64:79]
    v_exp_f32 v6, v50
    v_add_f32 v252, v4, v5
    v_cvt_pk_bf16_f32 v192, v4, v5
    v_mfma_f32_32x32x16_bf16 v[16:31], v[116:119], v[204:207], v[16:31]
    v_exp_f32 v7, v51
    v_add_f32 v252, v252, v6
    v_exp_f32 v4, v52
    v_mfma_f32_32x32x16_bf16 v[16:31], v[120:123], v[208:211], v[16:31]
    v_add_f32 v252, v252, v7
    v_cvt_pk_bf16_f32 v193, v6, v7
    v_exp_f32 v5, v53
    v_mfma_f32_32x32x16_bf16 v[16:31], v[124:127], v[212:215], v[16:31]
    v_add_f32 v252, v252, v4
    v_exp_f32 v6, v54
    v_add_f32 v252, v252, v5
    v_cvt_pk_bf16_f32 v194, v4, v5
    s_waitcnt lgkmcnt(0)
    v_mfma_f32_32x32x16_bf16 v[16:31], v[128:131], a[192:195], v[16:31]
    v_exp_f32 v7, v55
    v_add_f32 v252, v252, v6
    v_exp_f32 v4, v56
    v_mfma_f32_32x32x16_bf16 v[16:31], v[132:135], a[196:199], v[16:31]
    v_add_f32 v252, v252, v7
    v_cvt_pk_bf16_f32 v195, v6, v7
    v_exp_f32 v5, v57
    v_mfma_f32_32x32x16_bf16 v[16:31], v[136:139], a[200:203], v[16:31]
    v_add_f32 v252, v252, v4
    v_exp_f32 v6, v58
    v_add_f32 v252, v252, v5
    v_mfma_f32_32x32x16_bf16 v[16:31], v[140:143], a[204:207], v[16:31]
    v_cvt_pk_bf16_f32 v196, v4, v5
    v_exp_f32 v7, v59
    v_add_f32 v252, v252, v6
    v_mfma_f32_32x32x16_bf16 a[64:79], v[144:147], v[184:187], a[64:79]
    v_exp_f32 v4, v60
    v_add_f32 v252, v252, v7
    v_cvt_pk_bf16_f32 v197, v6, v7
    v_mfma_f32_32x32x16_bf16 a[80:95], v[148:151], v[184:187], a[80:95]
    v_exp_f32 v5, v61
    v_add_f32 v252, v252, v4
    v_exp_f32 v6, v62
    v_mfma_f32_32x32x16_bf16 a[96:111], v[152:155], v[184:187], a[96:111]
    v_add_f32 v252, v252, v5
    v_cvt_pk_bf16_f32 v198, v4, v5
    v_exp_f32 v7, v63
    v_add_f32 v252, v252, v6
    v_mfma_f32_32x32x16_bf16 a[112:127], v[156:159], v[184:187], a[112:127]
    s_mov_b32 s5, 442368
    buffer_load_dword v13, v255, s[60:63], s5 offen
    v_mfma_f32_32x32x16_bf16 a[64:79], v[160:163], v[188:191], a[64:79]
    v_add_f32 v252, v252, v7
    v_cvt_pk_bf16_f32 v199, v6, v7
    v_exp_f32 v4, v16
    v_mfma_f32_32x32x16_bf16 a[80:95], v[164:167], v[188:191], a[80:95]
    v_cmp_lt_f32 vcc, s51, v252
    v_exp_f32 v5, v17
    v_mfma_f32_32x32x16_bf16 a[96:111], v[168:171], v[188:191], a[96:111]
    s_cbranch_vccnz L_tr18
L_back18:
    v_add_f32 v249, v249, v252
    v_exp_f32 v6, v18
    v_add_f32 v250, v4, v5
    v_mfma_f32_32x32x16_bf16 a[112:127], v[172:175], v[188:191], a[112:127]
    v_cvt_pk_bf16_f32 v176, v4, v5
    v_exp_f32 v7, v19
    v_add_f32 v250, v250, v6
    v_mfma_f32_32x32x16_bf16 v[32:47], v[112:115], v[216:219], v[80:95]
    v_exp_f32 v4, v20
    v_add_f32 v250, v250, v7
    v_cvt_pk_bf16_f32 v177, v6, v7
    v_exp_f32 v5, v21
    v_mfma_f32_32x32x16_bf16 v[32:47], v[116:119], v[220:223], v[32:47]
    v_add_f32 v250, v250, v4
    v_exp_f32 v6, v22
    v_add_f32 v250, v250, v5
    v_mfma_f32_32x32x16_bf16 v[32:47], v[120:123], v[224:227], v[32:47]
    v_cvt_pk_bf16_f32 v178, v4, v5
    v_exp_f32 v7, v23
    v_add_f32 v250, v250, v6
    v_mfma_f32_32x32x16_bf16 v[32:47], v[124:127], v[228:231], v[32:47]
    v_exp_f32 v4, v24
    v_add_f32 v250, v250, v7
    v_cvt_pk_bf16_f32 v179, v6, v7
    v_mfma_f32_32x32x16_bf16 v[32:47], v[128:131], a[208:211], v[32:47]
    v_exp_f32 v5, v25
    v_add_f32 v250, v250, v4
    v_exp_f32 v6, v26
    v_mfma_f32_32x32x16_bf16 v[32:47], v[132:135], a[212:215], v[32:47]
    v_add_f32 v250, v250, v5
    v_cvt_pk_bf16_f32 v180, v4, v5
    v_exp_f32 v7, v27
    v_mfma_f32_32x32x16_bf16 v[32:47], v[136:139], a[216:219], v[32:47]
    v_add_f32 v250, v250, v6
    v_exp_f32 v4, v28
    v_add_f32 v250, v250, v7
    v_cvt_pk_bf16_f32 v181, v6, v7
    v_mfma_f32_32x32x16_bf16 v[32:47], v[140:143], a[220:223], v[32:47]
    v_exp_f32 v5, v29
    v_add_f32 v250, v250, v4
    v_exp_f32 v6, v30
    v_mfma_f32_32x32x16_bf16 a[128:143], v[144:147], v[192:195], a[128:143]
    s_waitcnt vmcnt(1)
    s_barrier
    v_add_f32 v250, v250, v5
    v_cvt_pk_bf16_f32 v182, v4, v5
    v_mfma_f32_32x32x16_bf16 a[144:159], v[148:151], v[192:195], a[144:159]
    ds_read_b64_tr_b16 v[144:145], v240 offset:49152
    s_mov_b32 s5, 589824
    buffer_load_dword v13, v255, s[60:63], s5 offen
    v_mfma_f32_32x32x16_bf16 a[160:175], v[152:155], v[192:195], a[160:175]
    v_exp_f32 v7, v31
    ds_read_b64_tr_b16 v[146:147], v240 offset:51200
    v_mfma_f32_32x32x16_bf16 a[176:191], v[156:159], v[192:195], a[176:191]
    v_add_f32 v250, v250, v6
    ds_read_b64_tr_b16 v[148:149], v241 offset:49152
    v_add_f32 v250, v250, v7
    v_cvt_pk_bf16_f32 v183, v6, v7
    v_mfma_f32_32x32x16_bf16 a[128:143], v[160:163], v[196:199], a[128:143]
    v_exp_f32 v4, v32
    ds_read_b64_tr_b16 v[150:151], v241 offset:51200
    v_cmp_lt_f32 vcc, s51, v250
    v_mfma_f32_32x32x16_bf16 a[144:159], v[164:167], v[196:199], a[144:159]
    v_exp_f32 v5, v33
    ds_read_b64_tr_b16 v[152:153], v242 offset:49152
    s_cbranch_vccnz L_tr19
L_back19:
    v_add_f32 v247, v247, v250
    v_mfma_f32_32x32x16_bf16 a[160:175], v[168:171], v[196:199], a[160:175]
    v_exp_f32 v6, v34
    ds_read_b64_tr_b16 v[154:155], v242 offset:51200
    v_add_f32 v251, v4, v5
    v_cvt_pk_bf16_f32 v184, v4, v5
    v_mfma_f32_32x32x16_bf16 a[176:191], v[172:175], v[196:199], a[176:191]
    v_exp_f32 v7, v35
    ds_read_b64_tr_b16 v[156:157], v243 offset:49152
    v_add_f32 v251, v251, v6
    v_mfma_f32_32x32x16_bf16 v[48:63], v[112:115], a[240:243], v[96:111]
    v_exp_f32 v4, v36
    ds_read_b64_tr_b16 v[158:159], v243 offset:51200
    v_add_f32 v251, v251, v7
    v_mfma_f32_32x32x16_bf16 v[48:63], v[116:119], a[244:247], v[48:63]
    v_cvt_pk_bf16_f32 v185, v6, v7
    ds_read_b64_tr_b16 v[160:161], v240 offset:53248
    v_exp_f32 v5, v37
    v_add_f32 v251, v251, v4
    v_mfma_f32_32x32x16_bf16 v[48:63], v[120:123], a[248:251], v[48:63]
    v_exp_f32 v6, v38
    ds_read_b64_tr_b16 v[162:163], v240 offset:55296
    v_add_f32 v251, v251, v5
    v_mfma_f32_32x32x16_bf16 v[48:63], v[124:127], a[252:255], v[48:63]
    v_cvt_pk_bf16_f32 v186, v4, v5
    ds_read_b64_tr_b16 v[164:165], v241 offset:53248
    v_exp_f32 v7, v39
    v_add_f32 v251, v251, v6
    v_mfma_f32_32x32x16_bf16 v[48:63], v[128:131], a[224:227], v[48:63]
    v_exp_f32 v4, v40
    ds_read_b64_tr_b16 v[166:167], v241 offset:55296
    v_add_f32 v251, v251, v7
    v_mfma_f32_32x32x16_bf16 v[48:63], v[132:135], a[228:231], v[48:63]
    ds_read_b64_tr_b16 v[168:169], v242 offset:53248
    s_mov_b32 s5, 737280
    buffer_load_dword v13, v255, s[60:63], s5 offen
    v_mfma_f32_32x32x16_bf16 v[48:63], v[136:139], a[232:235], v[48:63]
    v_cvt_pk_bf16_f32 v187, v6, v7
    ds_read_b64_tr_b16 v[170:171], v242 offset:55296
    v_exp_f32 v5, v41
    v_mfma_f32_32x32x16_bf16 v[48:63], v[140:143], a[236:239], v[48:63]
    v_add_f32 v251, v251, v4
    ds_read_b64_tr_b16 v[172:173], v243 offset:53248
    v_exp_f32 v6, v42
    s_waitcnt lgkmcnt(4)
    v_mfma_f32_32x32x16_bf16 a[0:15], v[144:147], v[176:179], a[0:15]
    v_add_f32 v251, v251, v5
    ds_read_b64_tr_b16 v[174:175], v243 offset:55296
    v_cvt_pk_bf16_f32 v188, v4, v5
    v_exp_f32 v7, v43
    v_mfma_f32_32x32x16_bf16 a[16:31], v[148:151], v[176:179], a[16:31]
    v_add_f32 v251, v251, v6
    v_exp_f32 v4, v44
    v_add_f32 v251, v251, v7
    v_mfma_f32_32x32x16_bf16 a[32:47], v[152:155], v[176:179], a[32:47]
    v_cvt_pk_bf16_f32 v189, v6, v7
    v_exp_f32 v5, v45
    v_add_f32 v251, v251, v4
    v_mfma_f32_32x32x16_bf16 a[48:63], v[156:159], v[176:179], a[48:63]
    v_exp_f32 v6, v46
    v_add_f32 v251, v251, v5
    v_cvt_pk_bf16_f32 v190, v4, v5
    v_mfma_f32_32x32x16_bf16 a[0:15], v[160:163], v[180:183], a[0:15]
    v_exp_f32 v7, v47
    v_add_f32 v251, v251, v6
    v_add_f32 v251, v251, v7
    v_cvt_pk_bf16_f32 v191, v6, v7
    s_waitcnt lgkmcnt(0)
    v_mfma_f32_32x32x16_bf16 a[16:31], v[164:167], v[180:183], a[16:31]
    v_exp_f32 v4, v48
    v_cmp_lt_f32 vcc, s51, v251
    v_exp_f32 v5, v49
    v_mfma_f32_32x32x16_bf16 a[32:47], v[168:171], v[180:183], a[32:47]
    s_cbranch_vccnz L_tr20
L_back20:
    v_add_f32 v248, v248, v251
    v_mfma_f32_32x32x16_bf16 a[48:63], v[172:175], v[180:183], a[48:63]
    v_mfma_f32_32x32x16_bf16 a[64:79], v[144:147], v[184:187], a[64:79]
    v_lshlrev_b32 v2, 4, v1
    s_mul_i32 s58, s40, 40960
    v_add_u32 v3, s58, v2
    v_exp_f32 v6, v50
    v_add_f32 v252, v4, v5
    v_cvt_pk_bf16_f32 v192, v4, v5
    v_exp_f32 v7, v51
    v_add_f32 v252, v252, v6
    v_mfma_f32_32x32x16_bf16 a[80:95], v[148:151], v[184:187], a[80:95]
    v_exp_f32 v4, v52
    v_add_f32 v252, v252, v7
    v_cvt_pk_bf16_f32 v193, v6, v7
    v_exp_f32 v5, v53
    v_add_f32 v252, v252, v4
    v_mfma_f32_32x32x16_bf16 a[96:111], v[152:155], v[184:187], a[96:111]
    s_mov_b32 s5, 884736
    buffer_load_dword v13, v255, s[60:63], s5 offen
    v_exp_f32 v6, v54
    v_add_f32 v252, v252, v5
    v_cvt_pk_bf16_f32 v194, v4, v5
    v_exp_f32 v7, v55
    v_add_f32 v252, v252, v6
    ds_write_b128 v3, a[32:35] offset:8192
    v_mfma_f32_32x32x16_bf16 a[112:127], v[156:159], v[184:187], a[112:127]
    v_exp_f32 v4, v56
    v_add_f32 v252, v252, v7
    v_cvt_pk_bf16_f32 v195, v6, v7
    v_exp_f32 v5, v57
    v_add_f32 v252, v252, v4
    ds_write_b128 v3, a[36:39] offset:9216
    v_mfma_f32_32x32x16_bf16 a[64:79], v[160:163], v[188:191], a[64:79]
    v_exp_f32 v6, v58
    v_add_f32 v252, v252, v5
    v_cvt_pk_bf16_f32 v196, v4, v5
    v_exp_f32 v7, v59
    v_add_f32 v252, v252, v6
    ds_write_b128 v3, a[40:43] offset:10240
    v_mfma_f32_32x32x16_bf16 a[80:95], v[164:167], v[188:191], a[80:95]
    v_exp_f32 v4, v60
    v_add_f32 v252, v252, v7
    v_cvt_pk_bf16_f32 v197, v6, v7
    v_exp_f32 v5, v61
    v_add_f32 v252, v252, v4
    ds_write_b128 v3, a[44:47] offset:11264
    v_mfma_f32_32x32x16_bf16 a[96:111], v[168:171], v[188:191], a[96:111]
    v_exp_f32 v6, v62
    v_add_f32 v252, v252, v5
    v_cvt_pk_bf16_f32 v198, v4, v5
    v_exp_f32 v7, v63
    v_add_f32 v252, v252, v6
    ds_write_b128 v3, a[48:51] offset:12288
    ds_write_b128 v3, a[52:55] offset:13312
    v_mfma_f32_32x32x16_bf16 a[112:127], v[172:175], v[188:191], a[112:127]
    v_add_f32 v252, v252, v7
    v_cvt_pk_bf16_f32 v199, v6, v7
    v_cmp_lt_f32 vcc, s51, v252
    s_cbranch_vccnz L_tr21
L_back21:
    v_add_f32 v249, v249, v252
    ds_write_b128 v3, a[56:59] offset:14336
    ds_write_b128 v3, a[60:63] offset:15360
    v_mfma_f32_32x32x16_bf16 a[128:143], v[144:147], v[192:195], a[128:143]
    v_mov_b32 v232, v247
    v_mov_b32 v233, v248
    v_mov_b32 v234, v249
    s_xor_b32 s56, s40, 2
    s_mul_i32 s57, s56, 40960
    v_permlane32_swap_b32 v232, v247
    v_permlane32_swap_b32 v233, v248
    v_mfma_f32_32x32x16_bf16 a[144:159], v[148:151], v[192:195], a[144:159]
    v_permlane32_swap_b32 v234, v249
    v_add_u32 v4, s57, v2
    v_add_f32 v237, v232, v247
    v_mov_b32 v236, v64
    v_add_f32 v239, v233, v248
    v_mov_b32 v238, v80
    v_add_f32 v241, v234, v249
    v_mfma_f32_32x32x16_bf16 a[160:175], v[152:155], v[192:195], a[160:175]
    v_mov_b32 v240, v96
    ds_write_b128 v3, v[236:239] offset:24576
    ds_write_b64 v3, v[240:241] offset:25600
    v_accvgpr_read_b32 v112, a0
    v_accvgpr_read_b32 v113, a1
    v_accvgpr_read_b32 v114, a2
    v_accvgpr_read_b32 v115, a3
    v_accvgpr_read_b32 v116, a4
    v_mfma_f32_32x32x16_bf16 a[176:191], v[156:159], v[192:195], a[176:191]
    v_accvgpr_read_b32 v117, a5
    v_accvgpr_read_b32 v118, a6
    v_accvgpr_read_b32 v119, a7
    ds_write_b128 v3, a[96:99] offset:16384
    v_accvgpr_read_b32 v120, a8
    v_accvgpr_read_b32 v121, a9
    v_accvgpr_read_b32 v122, a10
    v_mfma_f32_32x32x16_bf16 a[128:143], v[160:163], v[196:199], a[128:143]
    ds_write_b128 v3, a[100:103] offset:17408
    v_accvgpr_read_b32 v123, a11
    v_accvgpr_read_b32 v124, a12
    v_accvgpr_read_b32 v125, a13
    ds_write_b128 v3, a[104:107] offset:18432
    v_accvgpr_read_b32 v126, a14
    s_mov_b32 s5, 1032192
    v_mfma_f32_32x32x16_bf16 a[144:159], v[164:167], v[196:199], a[144:159]
    buffer_load_dword v13, v255, s[60:63], s5 offen
    v_accvgpr_read_b32 v127, a15
    v_accvgpr_read_b32 v128, a16
    ds_write_b128 v3, a[108:111] offset:19456
    v_accvgpr_read_b32 v129, a17
    v_accvgpr_read_b32 v130, a18
    v_accvgpr_read_b32 v131, a19
    ds_write_b128 v3, a[112:115] offset:20480
    v_mfma_f32_32x32x16_bf16 a[160:175], v[168:171], v[196:199], a[160:175]
    v_accvgpr_read_b32 v132, a20
    v_accvgpr_read_b32 v133, a21
    v_accvgpr_read_b32 v134, a22
    ds_write_b128 v3, a[116:119] offset:21504
    v_accvgpr_read_b32 v135, a23
    v_accvgpr_read_b32 v136, a24
    v_accvgpr_read_b32 v137, a25
    v_mfma_f32_32x32x16_bf16 a[176:191], v[172:175], v[196:199], a[176:191]
    ds_write_b128 v3, a[120:123] offset:22528
    v_accvgpr_read_b32 v138, a26
    v_accvgpr_read_b32 v139, a27
    v_accvgpr_read_b32 v140, a28
    ds_write_b128 v3, a[124:127] offset:23552
    v_accvgpr_read_b32 v141, a29
    v_accvgpr_read_b32 v142, a30
    v_accvgpr_read_b32 v143, a31
    s_waitcnt lgkmcnt(0)
    s_barrier
    ds_read_b128 v[244:247], v4 offset:24576
    ds_read_b64 v[248:249], v4 offset:25600
    ds_read_b128 v[16:19], v4 offset:8192
    ds_read_b128 v[20:23], v4 offset:9216
    ds_read_b128 v[24:27], v4 offset:10240
    ds_read_b128 v[28:31], v4 offset:11264
    ds_read_b128 v[32:35], v4 offset:12288
    ds_read_b128 v[36:39], v4 offset:13312
    ds_read_b128 v[40:43], v4 offset:14336
    ds_read_b128 v[44:47], v4 offset:15360
    s_lshl_b32 s3, s45, 4
    s_lshl_b32 s56, s41, 3
    s_add_u32 s3, s3, s56
    s_lshl_b32 s56, s42, 2
    s_add_u32 s3, s3, s56
    s_mul_i32 s56, s44, 768
    s_add_u32 s3, s3, s56
    s_lshl_b32 s4, s3, 10
    ds_write_b128 v3, a[160:163] offset:32768
    v_accvgpr_read_b32 v144, a64
    v_accvgpr_read_b32 v145, a65
    v_accvgpr_read_b32 v146, a66
    v_accvgpr_read_b32 v147, a67
    ds_write_b128 v3, a[164:167] offset:33792
    v_accvgpr_read_b32 v148, a68
    v_accvgpr_read_b32 v149, a69
    v_accvgpr_read_b32 v150, a70
    v_accvgpr_read_b32 v151, a71
    ds_write_b128 v3, a[168:171] offset:34816
    v_accvgpr_read_b32 v152, a72
    v_accvgpr_read_b32 v153, a73
    v_accvgpr_read_b32 v154, a74
    v_accvgpr_read_b32 v155, a75
    ds_write_b128 v3, a[172:175] offset:35840
    v_accvgpr_read_b32 v156, a76
    v_accvgpr_read_b32 v157, a77
    v_accvgpr_read_b32 v158, a78
    v_accvgpr_read_b32 v159, a79
    ds_write_b128 v3, a[176:179] offset:36864
    v_accvgpr_read_b32 v160, a80
    v_accvgpr_read_b32 v161, a81
    v_accvgpr_read_b32 v162, a82
    v_accvgpr_read_b32 v163, a83
    ds_write_b128 v3, a[180:183] offset:37888
    v_accvgpr_read_b32 v164, a84
    v_accvgpr_read_b32 v165, a85
    v_accvgpr_read_b32 v166, a86
    v_accvgpr_read_b32 v167, a87
    ds_write_b128 v3, a[184:187] offset:38912
    v_accvgpr_read_b32 v168, a88
    v_accvgpr_read_b32 v169, a89
    v_accvgpr_read_b32 v170, a90
    v_accvgpr_read_b32 v171, a91
    ds_write_b128 v3, a[188:191] offset:39936
    v_accvgpr_read_b32 v172, a92
    v_accvgpr_read_b32 v173, a93
    v_accvgpr_read_b32 v174, a94
    v_accvgpr_read_b32 v175, a95
    ds_read_b128 v[48:51], v4 offset:16384
    ds_read_b128 v[52:55], v4 offset:17408
    ds_read_b128 v[56:59], v4 offset:18432
    ds_read_b128 v[60:63], v4 offset:19456
    ds_read_b128 v[64:67], v4 offset:20480
    ds_read_b128 v[68:71], v4 offset:21504
    ds_read_b128 v[72:75], v4 offset:22528
    ds_read_b128 v[76:79], v4 offset:23552
    s_waitcnt lgkmcnt(15)
    v_min_f32 v8, v236, v244
    v_min_f32 v9, v238, v246
    v_min_f32 v10, v240, v248
    v_sub_f32 v176, v8, v236
    v_sub_f32 v178, v8, v244
    v_sub_f32 v180, v9, v238
    v_sub_f32 v182, v9, v246
    v_sub_f32 v184, v10, v240
    v_sub_f32 v186, v10, v248
    v_exp_f32 v176, v176
    v_exp_f32 v178, v178
    v_exp_f32 v180, v180
    v_exp_f32 v182, v182
    v_exp_f32 v184, v184
    v_exp_f32 v186, v186
    v_mul_f32 v8, v237, v176
    v_mul_f32 v9, v239, v180
    v_mul_f32 v10, v241, v184
    v_fmac_f32 v8, v245, v178
    v_fmac_f32 v9, v247, v182
    v_fmac_f32 v10, v249, v186
    v_rcp_f32 v8, v8
    v_rcp_f32 v9, v9
    v_rcp_f32 v10, v10
    s_nop 0
    v_mul_f32 v176, v176, v8
    v_mul_f32 v178, v178, v8
    v_mul_f32 v180, v180, v9
    v_mul_f32 v182, v182, v9
    v_mul_f32 v184, v184, v10
    v_mul_f32 v186, v186, v10
    v_pk_mul_f32 v[16:17], v[16:17], v[178:179] op_sel_hi:[1,0]
    v_pk_mul_f32 v[18:19], v[18:19], v[178:179] op_sel_hi:[1,0]
    v_pk_mul_f32 v[20:21], v[20:21], v[178:179] op_sel_hi:[1,0]
    v_pk_mul_f32 v[22:23], v[22:23], v[178:179] op_sel_hi:[1,0]
    v_pk_mul_f32 v[24:25], v[24:25], v[178:179] op_sel_hi:[1,0]
    v_pk_mul_f32 v[26:27], v[26:27], v[178:179] op_sel_hi:[1,0]
    v_pk_mul_f32 v[28:29], v[28:29], v[178:179] op_sel_hi:[1,0]
    v_pk_mul_f32 v[30:31], v[30:31], v[178:179] op_sel_hi:[1,0]
    v_pk_fma_f32 v[16:17], v[112:113], v[176:177], v[16:17] op_sel_hi:[1,0,1]
    v_pk_fma_f32 v[18:19], v[114:115], v[176:177], v[18:19] op_sel_hi:[1,0,1]
    v_pk_fma_f32 v[20:21], v[116:117], v[176:177], v[20:21] op_sel_hi:[1,0,1]
    v_pk_fma_f32 v[22:23], v[118:119], v[176:177], v[22:23] op_sel_hi:[1,0,1]
    v_pk_fma_f32 v[24:25], v[120:121], v[176:177], v[24:25] op_sel_hi:[1,0,1]
    v_pk_fma_f32 v[26:27], v[122:123], v[176:177], v[26:27] op_sel_hi:[1,0,1]
    v_pk_fma_f32 v[28:29], v[124:125], v[176:177], v[28:29] op_sel_hi:[1,0,1]
    v_pk_fma_f32 v[30:31], v[126:127], v[176:177], v[30:31] op_sel_hi:[1,0,1]
    v_cvt_pk_bf16_f32 v200, v16, v17
    v_cvt_pk_bf16_f32 v201, v18, v19
    v_cvt_pk_bf16_f32 v202, v20, v21
    v_cvt_pk_bf16_f32 v203, v22, v23
    v_cvt_pk_bf16_f32 v204, v24, v25
    v_cvt_pk_bf16_f32 v205, v26, v27
    v_cvt_pk_bf16_f32 v206, v28, v29
    v_cvt_pk_bf16_f32 v207, v30, v31
    buffer_store_dwordx4 v[200:203], v2, s[28:31], s4 offen offset:0 sc1
    buffer_store_dwordx4 v[204:207], v2, s[28:31], s4 offen offset:1024 sc1
    v_pk_mul_f32 v[32:33], v[32:33], v[178:179] op_sel_hi:[1,0]
    v_pk_mul_f32 v[34:35], v[34:35], v[178:179] op_sel_hi:[1,0]
    v_pk_mul_f32 v[36:37], v[36:37], v[178:179] op_sel_hi:[1,0]
    v_pk_mul_f32 v[38:39], v[38:39], v[178:179] op_sel_hi:[1,0]
    v_pk_mul_f32 v[40:41], v[40:41], v[178:179] op_sel_hi:[1,0]
    v_pk_mul_f32 v[42:43], v[42:43], v[178:179] op_sel_hi:[1,0]
    v_pk_mul_f32 v[44:45], v[44:45], v[178:179] op_sel_hi:[1,0]
    v_pk_mul_f32 v[46:47], v[46:47], v[178:179] op_sel_hi:[1,0]
    v_pk_fma_f32 v[32:33], v[128:129], v[176:177], v[32:33] op_sel_hi:[1,0,1]
    v_pk_fma_f32 v[34:35], v[130:131], v[176:177], v[34:35] op_sel_hi:[1,0,1]
    v_pk_fma_f32 v[36:37], v[132:133], v[176:177], v[36:37] op_sel_hi:[1,0,1]
    v_pk_fma_f32 v[38:39], v[134:135], v[176:177], v[38:39] op_sel_hi:[1,0,1]
    v_pk_fma_f32 v[40:41], v[136:137], v[176:177], v[40:41] op_sel_hi:[1,0,1]
    v_pk_fma_f32 v[42:43], v[138:139], v[176:177], v[42:43] op_sel_hi:[1,0,1]
    v_pk_fma_f32 v[44:45], v[140:141], v[176:177], v[44:45] op_sel_hi:[1,0,1]
    v_pk_fma_f32 v[46:47], v[142:143], v[176:177], v[46:47] op_sel_hi:[1,0,1]
    v_cvt_pk_bf16_f32 v208, v32, v33
    v_cvt_pk_bf16_f32 v209, v34, v35
    v_cvt_pk_bf16_f32 v210, v36, v37
    v_cvt_pk_bf16_f32 v211, v38, v39
    v_cvt_pk_bf16_f32 v212, v40, v41
    v_cvt_pk_bf16_f32 v213, v42, v43
    v_cvt_pk_bf16_f32 v214, v44, v45
    v_cvt_pk_bf16_f32 v215, v46, v47
    buffer_store_dwordx4 v[208:211], v2, s[28:31], s4 offen offset:2048 sc1
    buffer_store_dwordx4 v[212:215], v2, s[28:31], s4 offen offset:3072 sc1
    s_add_u32 s4, s4, 262144
    s_waitcnt lgkmcnt(0)
    s_barrier
    ds_read_b128 v[80:83], v4 offset:32768
    ds_read_b128 v[84:87], v4 offset:33792
    ds_read_b128 v[88:91], v4 offset:34816
    ds_read_b128 v[92:95], v4 offset:35840
    ds_read_b128 v[96:99], v4 offset:36864
    ds_read_b128 v[100:103], v4 offset:37888
    ds_read_b128 v[104:107], v4 offset:38912
    ds_read_b128 v[108:111], v4 offset:39936
    v_pk_mul_f32 v[48:49], v[48:49], v[182:183] op_sel_hi:[1,0]
    v_pk_mul_f32 v[50:51], v[50:51], v[182:183] op_sel_hi:[1,0]
    v_pk_mul_f32 v[52:53], v[52:53], v[182:183] op_sel_hi:[1,0]
    v_pk_mul_f32 v[54:55], v[54:55], v[182:183] op_sel_hi:[1,0]
    v_pk_mul_f32 v[56:57], v[56:57], v[182:183] op_sel_hi:[1,0]
    v_pk_mul_f32 v[58:59], v[58:59], v[182:183] op_sel_hi:[1,0]
    v_pk_mul_f32 v[60:61], v[60:61], v[182:183] op_sel_hi:[1,0]
    v_pk_mul_f32 v[62:63], v[62:63], v[182:183] op_sel_hi:[1,0]
    v_pk_fma_f32 v[48:49], v[144:145], v[180:181], v[48:49] op_sel_hi:[1,0,1]
    v_pk_fma_f32 v[50:51], v[146:147], v[180:181], v[50:51] op_sel_hi:[1,0,1]
    v_pk_fma_f32 v[52:53], v[148:149], v[180:181], v[52:53] op_sel_hi:[1,0,1]
    v_pk_fma_f32 v[54:55], v[150:151], v[180:181], v[54:55] op_sel_hi:[1,0,1]
    v_pk_fma_f32 v[56:57], v[152:153], v[180:181], v[56:57] op_sel_hi:[1,0,1]
    v_pk_fma_f32 v[58:59], v[154:155], v[180:181], v[58:59] op_sel_hi:[1,0,1]
    v_pk_fma_f32 v[60:61], v[156:157], v[180:181], v[60:61] op_sel_hi:[1,0,1]
    v_pk_fma_f32 v[62:63], v[158:159], v[180:181], v[62:63] op_sel_hi:[1,0,1]
    v_cvt_pk_bf16_f32 v216, v48, v49
    v_cvt_pk_bf16_f32 v217, v50, v51
    v_cvt_pk_bf16_f32 v218, v52, v53
    v_cvt_pk_bf16_f32 v219, v54, v55
    v_cvt_pk_bf16_f32 v220, v56, v57
    v_cvt_pk_bf16_f32 v221, v58, v59
    v_cvt_pk_bf16_f32 v222, v60, v61
    v_cvt_pk_bf16_f32 v223, v62, v63
    buffer_store_dwordx4 v[216:219], v2, s[28:31], s4 offen offset:0 sc1
    buffer_store_dwordx4 v[220:223], v2, s[28:31], s4 offen offset:1024 sc1
    v_pk_mul_f32 v[64:65], v[64:65], v[182:183] op_sel_hi:[1,0]
    v_pk_mul_f32 v[66:67], v[66:67], v[182:183] op_sel_hi:[1,0]
    v_pk_mul_f32 v[68:69], v[68:69], v[182:183] op_sel_hi:[1,0]
    v_pk_mul_f32 v[70:71], v[70:71], v[182:183] op_sel_hi:[1,0]
    v_pk_mul_f32 v[72:73], v[72:73], v[182:183] op_sel_hi:[1,0]
    v_pk_mul_f32 v[74:75], v[74:75], v[182:183] op_sel_hi:[1,0]
    v_pk_mul_f32 v[76:77], v[76:77], v[182:183] op_sel_hi:[1,0]
    v_pk_mul_f32 v[78:79], v[78:79], v[182:183] op_sel_hi:[1,0]
    v_pk_fma_f32 v[64:65], v[160:161], v[180:181], v[64:65] op_sel_hi:[1,0,1]
    v_pk_fma_f32 v[66:67], v[162:163], v[180:181], v[66:67] op_sel_hi:[1,0,1]
    v_pk_fma_f32 v[68:69], v[164:165], v[180:181], v[68:69] op_sel_hi:[1,0,1]
    v_pk_fma_f32 v[70:71], v[166:167], v[180:181], v[70:71] op_sel_hi:[1,0,1]
    v_pk_fma_f32 v[72:73], v[168:169], v[180:181], v[72:73] op_sel_hi:[1,0,1]
    v_pk_fma_f32 v[74:75], v[170:171], v[180:181], v[74:75] op_sel_hi:[1,0,1]
    v_pk_fma_f32 v[76:77], v[172:173], v[180:181], v[76:77] op_sel_hi:[1,0,1]
    v_pk_fma_f32 v[78:79], v[174:175], v[180:181], v[78:79] op_sel_hi:[1,0,1]
    v_cvt_pk_bf16_f32 v224, v64, v65
    v_cvt_pk_bf16_f32 v225, v66, v67
    v_cvt_pk_bf16_f32 v226, v68, v69
    v_cvt_pk_bf16_f32 v227, v70, v71
    v_cvt_pk_bf16_f32 v228, v72, v73
    v_cvt_pk_bf16_f32 v229, v74, v75
    v_cvt_pk_bf16_f32 v230, v76, v77
    v_cvt_pk_bf16_f32 v231, v78, v79
    buffer_store_dwordx4 v[224:227], v2, s[28:31], s4 offen offset:2048 sc1
    buffer_store_dwordx4 v[228:231], v2, s[28:31], s4 offen offset:3072 sc1
    s_add_u32 s4, s4, 262144
    v_accvgpr_read_b32 v112, a128
    v_accvgpr_read_b32 v113, a129
    v_accvgpr_read_b32 v114, a130
    v_accvgpr_read_b32 v115, a131
    v_accvgpr_read_b32 v116, a132
    v_accvgpr_read_b32 v117, a133
    v_accvgpr_read_b32 v118, a134
    v_accvgpr_read_b32 v119, a135
    v_accvgpr_read_b32 v120, a136
    v_accvgpr_read_b32 v121, a137
    v_accvgpr_read_b32 v122, a138
    v_accvgpr_read_b32 v123, a139
    v_accvgpr_read_b32 v124, a140
    v_accvgpr_read_b32 v125, a141
    v_accvgpr_read_b32 v126, a142
    v_accvgpr_read_b32 v127, a143
    s_waitcnt lgkmcnt(7)
    v_pk_mul_f32 v[80:81], v[80:81], v[186:187] op_sel_hi:[1,0]
    v_pk_mul_f32 v[82:83], v[82:83], v[186:187] op_sel_hi:[1,0]
    s_waitcnt lgkmcnt(6)
    v_pk_mul_f32 v[84:85], v[84:85], v[186:187] op_sel_hi:[1,0]
    v_pk_mul_f32 v[86:87], v[86:87], v[186:187] op_sel_hi:[1,0]
    s_waitcnt lgkmcnt(5)
    v_pk_mul_f32 v[88:89], v[88:89], v[186:187] op_sel_hi:[1,0]
    v_pk_mul_f32 v[90:91], v[90:91], v[186:187] op_sel_hi:[1,0]
    s_waitcnt lgkmcnt(4)
    v_pk_mul_f32 v[92:93], v[92:93], v[186:187] op_sel_hi:[1,0]
    v_pk_mul_f32 v[94:95], v[94:95], v[186:187] op_sel_hi:[1,0]
    v_pk_fma_f32 v[80:81], v[112:113], v[184:185], v[80:81] op_sel_hi:[1,0,1]
    v_pk_fma_f32 v[82:83], v[114:115], v[184:185], v[82:83] op_sel_hi:[1,0,1]
    v_pk_fma_f32 v[84:85], v[116:117], v[184:185], v[84:85] op_sel_hi:[1,0,1]
    v_pk_fma_f32 v[86:87], v[118:119], v[184:185], v[86:87] op_sel_hi:[1,0,1]
    v_pk_fma_f32 v[88:89], v[120:121], v[184:185], v[88:89] op_sel_hi:[1,0,1]
    v_pk_fma_f32 v[90:91], v[122:123], v[184:185], v[90:91] op_sel_hi:[1,0,1]
    v_pk_fma_f32 v[92:93], v[124:125], v[184:185], v[92:93] op_sel_hi:[1,0,1]
    v_pk_fma_f32 v[94:95], v[126:127], v[184:185], v[94:95] op_sel_hi:[1,0,1]
    v_cvt_pk_bf16_f32 v200, v80, v81
    v_cvt_pk_bf16_f32 v201, v82, v83
    v_cvt_pk_bf16_f32 v202, v84, v85
    v_cvt_pk_bf16_f32 v203, v86, v87
    v_cvt_pk_bf16_f32 v204, v88, v89
    v_cvt_pk_bf16_f32 v205, v90, v91
    v_cvt_pk_bf16_f32 v206, v92, v93
    v_cvt_pk_bf16_f32 v207, v94, v95
    buffer_store_dwordx4 v[200:203], v2, s[28:31], s4 offen offset:0 sc1
    buffer_store_dwordx4 v[204:207], v2, s[28:31], s4 offen offset:1024 sc1
    v_accvgpr_read_b32 v128, a144
    v_accvgpr_read_b32 v129, a145
    v_accvgpr_read_b32 v130, a146
    v_accvgpr_read_b32 v131, a147
    v_accvgpr_read_b32 v132, a148
    v_accvgpr_read_b32 v133, a149
    v_accvgpr_read_b32 v134, a150
    v_accvgpr_read_b32 v135, a151
    v_accvgpr_read_b32 v136, a152
    v_accvgpr_read_b32 v137, a153
    v_accvgpr_read_b32 v138, a154
    v_accvgpr_read_b32 v139, a155
    v_accvgpr_read_b32 v140, a156
    v_accvgpr_read_b32 v141, a157
    v_accvgpr_read_b32 v142, a158
    v_accvgpr_read_b32 v143, a159
    s_waitcnt lgkmcnt(3)
    v_pk_mul_f32 v[96:97], v[96:97], v[186:187] op_sel_hi:[1,0]
    v_pk_mul_f32 v[98:99], v[98:99], v[186:187] op_sel_hi:[1,0]
    s_waitcnt lgkmcnt(2)
    v_pk_mul_f32 v[100:101], v[100:101], v[186:187] op_sel_hi:[1,0]
    v_pk_mul_f32 v[102:103], v[102:103], v[186:187] op_sel_hi:[1,0]
    s_waitcnt lgkmcnt(1)
    v_pk_mul_f32 v[104:105], v[104:105], v[186:187] op_sel_hi:[1,0]
    v_pk_mul_f32 v[106:107], v[106:107], v[186:187] op_sel_hi:[1,0]
    s_waitcnt lgkmcnt(0)
    v_pk_mul_f32 v[108:109], v[108:109], v[186:187] op_sel_hi:[1,0]
    v_pk_mul_f32 v[110:111], v[110:111], v[186:187] op_sel_hi:[1,0]
    v_pk_fma_f32 v[96:97], v[128:129], v[184:185], v[96:97] op_sel_hi:[1,0,1]
    v_pk_fma_f32 v[98:99], v[130:131], v[184:185], v[98:99] op_sel_hi:[1,0,1]
    v_pk_fma_f32 v[100:101], v[132:133], v[184:185], v[100:101] op_sel_hi:[1,0,1]
    v_pk_fma_f32 v[102:103], v[134:135], v[184:185], v[102:103] op_sel_hi:[1,0,1]
    v_pk_fma_f32 v[104:105], v[136:137], v[184:185], v[104:105] op_sel_hi:[1,0,1]
    v_pk_fma_f32 v[106:107], v[138:139], v[184:185], v[106:107] op_sel_hi:[1,0,1]
    v_pk_fma_f32 v[108:109], v[140:141], v[184:185], v[108:109] op_sel_hi:[1,0,1]
    v_pk_fma_f32 v[110:111], v[142:143], v[184:185], v[110:111] op_sel_hi:[1,0,1]
    v_cvt_pk_bf16_f32 v208, v96, v97
    v_cvt_pk_bf16_f32 v209, v98, v99
    v_cvt_pk_bf16_f32 v210, v100, v101
    v_cvt_pk_bf16_f32 v211, v102, v103
    v_cvt_pk_bf16_f32 v212, v104, v105
    v_cvt_pk_bf16_f32 v213, v106, v107
    v_cvt_pk_bf16_f32 v214, v108, v109
    v_cvt_pk_bf16_f32 v215, v110, v111
    buffer_store_dwordx4 v[208:211], v2, s[28:31], s4 offen offset:2048 sc1
    buffer_store_dwordx4 v[212:215], v2, s[28:31], s4 offen offset:3072 sc1
    s_barrier
    s_mul_i32 s58, s40, 40960
    s_mul_i32 s57, s40, 1179648
    v_lshrrev_b32 v11, 3, v1
    v_and_b32 v12, 7, v1
    v_bfe_u32 v10, v1, 4, 1
    v_lshlrev_b32 v10, 2, v10
    v_xor_b32 v10, v10, v12
    v_lshlrev_b32 v10, 4, v10
    v_mul_u32_u24 v11, 1152, v11
    v_add_u32 v6, v11, v10
    v_add_u32 v7, 8192, v6
    v_add_u32 v8, 16384, v6
    v_add_u32 v9, 24576, v6
    v_lshrrev_b32 v11, 5, v1
    v_bfe_u32 v12, v1, 2, 2
    v_lshl_add_u32 v11, v11, 2, v12
    v_lshlrev_b32 v11, 7, v11
    v_bfe_u32 v12, v1, 3, 1
    v_lshl_add_u32 v11, v12, 6, v11
    v_bfe_u32 v12, v1, 4, 1
    v_lshl_add_u32 v11, v12, 5, v11
    v_and_b32 v12, 1, v1
    v_lshl_add_u32 v11, v12, 4, v11
    v_bfe_u32 v12, v1, 1, 1
    v_lshl_add_u32 v11, v12, 3, v11
    s_lshl_b32 s3, s42, 6
    v_xor_b32 v11, s3, v11
    v_add_u32 v4, s58, v11
    v_xor_b32 v5, 64, v4
    s_lshl_b32 s3, s90, 19
    s_lshl_b32 s56, s40, 16
    s_add_u32 s3, s3, s56
    s_lshl_b32 s56, s41, 18
    s_add_u32 s3, s3, s56
    v_lshlrev_b32 v11, 4, v1
    v_add_u32 v14, s3, v11
    v_xor_b32 v15, 0x40000, v14
    s_cmp_eq_u32 s92, 1
    s_cbranch_scc1 L_notile
    s_add_u32 m0, s58, 0
    s_add_u32 s59, s57, 0
    buffer_load_dwordx4 v6, s[24:27], s59 offen offset:0 lds
    buffer_load_dwordx4 v7, s[24:27], s59 offen offset:1024 lds
    buffer_load_dwordx4 v8, s[24:27], s59 offen offset:2048 lds
    buffer_load_dwordx4 v9, s[24:27], s59 offen offset:3072 lds
    s_add_u32 m0, s58, 4096
    s_add_u32 s59, s57, 36864
    buffer_load_dwordx4 v6, s[24:27], s59 offen offset:0 lds
    buffer_load_dwordx4 v7, s[24:27], s59 offen offset:1024 lds
    buffer_load_dwordx4 v8, s[24:27], s59 offen offset:2048 lds
    buffer_load_dwordx4 v9, s[24:27], s59 offen offset:3072 lds
    s_add_u32 m0, s58, 8192
    s_add_u32 s59, s57, 73728
    buffer_load_dwordx4 v6, s[24:27], s59 offen offset:0 lds
    buffer_load_dwordx4 v7, s[24:27], s59 offen offset:1024 lds
    buffer_load_dwordx4 v8, s[24:27], s59 offen offset:2048 lds
    buffer_load_dwordx4 v9, s[24:27], s59 offen offset:3072 lds
    s_add_u32 m0, s58, 12288
    s_add_u32 s59, s57, 110592
    buffer_load_dwordx4 v6, s[24:27], s59 offen offset:0 lds
    buffer_load_dwordx4 v7, s[24:27], s59 offen offset:1024 lds
    buffer_load_dwordx4 v8, s[24:27], s59 offen offset:2048 lds
    buffer_load_dwordx4 v9, s[24:27], s59 offen offset:3072 lds
    s_add_u32 m0, s58, 16384
    s_add_u32 s59, s57, 147456
    buffer_load_dwordx4 v6, s[24:27], s59 offen offset:0 lds
    buffer_load_dwordx4 v7, s[24:27], s59 offen offset:1024 lds
    buffer_load_dwordx4 v8, s[24:27], s59 offen offset:2048 lds
    buffer_load_dwordx4 v9, s[24:27], s59 offen offset:3072 lds
    s_add_u32 m0, s58, 20480
    s_add_u32 s59, s57, 184320
    buffer_load_dwordx4 v6, s[24:27], s59 offen offset:0 lds
    buffer_load_dwordx4 v7, s[24:27], s59 offen offset:1024 lds
    buffer_load_dwordx4 v8, s[24:27], s59 offen offset:2048 lds
    buffer_load_dwordx4 v9, s[24:27], s59 offen offset:3072 lds
    s_add_u32 m0, s58, 24576
    s_add_u32 s59, s57, 221184
    buffer_load_dwordx4 v6, s[24:27], s59 offen offset:0 lds
    buffer_load_dwordx4 v7, s[24:27], s59 offen offset:1024 lds
    buffer_load_dwordx4 v8, s[24:27], s59 offen offset:2048 lds
    buffer_load_dwordx4 v9, s[24:27], s59 offen offset:3072 lds
    s_add_u32 m0, s58, 28672
    s_add_u32 s59, s57, 258048
    buffer_load_dwordx4 v6, s[24:27], s59 offen offset:0 lds
    buffer_load_dwordx4 v7, s[24:27], s59 offen offset:1024 lds
    buffer_load_dwordx4 v8, s[24:27], s59 offen offset:2048 lds
    buffer_load_dwordx4 v9, s[24:27], s59 offen offset:3072 lds
    s_waitcnt vmcnt(32)
    s_barrier
    s_cmp_lg_u32 s40, 0
    s_cbranch_scc1 L_nosig
    s_lshl_b32 s3, s43, 3
    s_add_u32 s3, s3, s44
    s_lshl_b32 s3, s3, 2
    s_lshr_b32 s56, s45, 2
    s_add_u32 s3, s3, s56
    s_lshl_b32 s3, s3, 2
    v_mov_b32 v10, 1
    s_mov_b64 exec, 1
    buffer_atomic_add v10, off, s[36:39], s3 sc1
    s_mov_b64 exec, -1
L_nosig:
    s_add_u32 m0, s58, 32768
    s_add_u32 s59, s57, 294912
    buffer_load_dwordx4 v6, s[24:27], s59 offen offset:0 lds
    buffer_load_dwordx4 v7, s[24:27], s59 offen offset:1024 lds
    buffer_load_dwordx4 v8, s[24:27], s59 offen offset:2048 lds
    buffer_load_dwordx4 v9, s[24:27], s59 offen offset:3072 lds
    s_add_u32 m0, s58, 36864
    s_add_u32 s59, s57, 331776
    buffer_load_dwordx4 v6, s[24:27], s59 offen offset:0 lds
    buffer_load_dwordx4 v7, s[24:27], s59 offen offset:1024 lds
    buffer_load_dwordx4 v8, s[24:27], s59 offen offset:2048 lds
    buffer_load_dwordx4 v9, s[24:27], s59 offen offset:3072 lds
    s_lshl_b32 s3, s90, 1
    s_mul_i32 s92, s3, 43
    s_lshr_b32 s92, s92, 7
    s_add_u32 s3, s3, 1
    s_mul_i32 s93, s3, 43
    s_lshr_b32 s93, s93, 7
    s_lshl_b32 s3, s43, 3
    s_add_u32 s92, s92, s3
    s_add_u32 s93, s93, s3
    s_lshl_b32 s92, s92, 4
    s_lshl_b32 s93, s93, 4
    s_lshl_b32 s3, s40, 2
    s_add_u32 s92, s92, s3
    s_add_u32 s93, s93, s3
    s_mov_b32 s50, 0
    s_waitcnt vmcnt(38)
    ds_read_b64_tr_b16 a[0:1], v4 offset:0
    ds_read_b64_tr_b16 a[2:3], v4 offset:1024
    ds_read_b64_tr_b16 a[4:5], v5 offset:0
    ds_read_b64_tr_b16 a[6:7], v5 offset:1024
    s_waitcnt vmcnt(36)
    ds_read_b64_tr_b16 a[8:9], v4 offset:2048
    ds_read_b64_tr_b16 a[10:11], v4 offset:3072
    ds_read_b64_tr_b16 a[12:13], v5 offset:2048
    ds_read_b64_tr_b16 a[14:15], v5 offset:3072
    s_waitcnt vmcnt(34)
    ds_read_b64_tr_b16 a[16:17], v4 offset:4096
    ds_read_b64_tr_b16 a[18:19], v4 offset:5120
    ds_read_b64_tr_b16 a[20:21], v5 offset:4096
    ds_read_b64_tr_b16 a[22:23], v5 offset:5120
    s_waitcnt lgkmcnt(4)
    s_add_u32 m0, s58, 0
    s_add_u32 s59, s57, 368640
    buffer_load_dwordx4 v6, s[24:27], s59 offen offset:0 lds
    buffer_load_dwordx4 v7, s[24:27], s59 offen offset:1024 lds
    buffer_load_dwordx4 v8, s[24:27], s59 offen offset:2048 lds
    buffer_load_dwordx4 v9, s[24:27], s59 offen offset:3072 lds
    s_waitcnt vmcnt(36)
    ds_read_b64_tr_b16 a[24:25], v4 offset:6144
    ds_read_b64_tr_b16 a[26:27], v4 offset:7168
    ds_read_b64_tr_b16 a[28:29], v5 offset:6144
    ds_read_b64_tr_b16 a[30:31], v5 offset:7168
    s_waitcnt vmcnt(34)
    ds_read_b64_tr_b16 a[32:33], v4 offset:8192
    ds_read_b64_tr_b16 a[34:35], v4 offset:9216
    ds_read_b64_tr_b16 a[36:37], v5 offset:8192
    ds_read_b64_tr_b16 a[38:39], v5 offset:9216
    s_waitcnt lgkmcnt(4)
    s_add_u32 m0, s58, 4096
    s_add_u32 s59, s57, 405504
    buffer_load_dwordx4 v6, s[24:27], s59 offen offset:0 lds
    buffer_load_dwordx4 v7, s[24:27], s59 offen offset:1024 lds
    buffer_load_dwordx4 v8, s[24:27], s59 offen offset:2048 lds
    buffer_load_dwordx4 v9, s[24:27], s59 offen offset:3072 lds
    s_waitcnt vmcnt(36)
    ds_read_b64_tr_b16 a[40:41], v4 offset:10240
    ds_read_b64_tr_b16 a[42:43], v4 offset:11264
    ds_read_b64_tr_b16 a[44:45], v5 offset:10240
    ds_read_b64_tr_b16 a[46:47], v5 offset:11264
    s_waitcnt vmcnt(34)
    ds_read_b64_tr_b16 a[48:49], v4 offset:12288
    ds_read_b64_tr_b16 a[50:51], v4 offset:13312
    ds_read_b64_tr_b16 a[52:53], v5 offset:12288
    ds_read_b64_tr_b16 a[54:55], v5 offset:13312
    s_waitcnt lgkmcnt(4)
    s_add_u32 m0, s58, 8192
    s_add_u32 s59, s57, 442368
    buffer_load_dwordx4 v6, s[24:27], s59 offen offset:0 lds
    buffer_load_dwordx4 v7, s[24:27], s59 offen offset:1024 lds
    buffer_load_dwordx4 v8, s[24:27], s59 offen offset:2048 lds
    buffer_load_dwordx4 v9, s[24:27], s59 offen offset:3072 lds
    s_waitcnt vmcnt(36)
    ds_read_b64_tr_b16 a[56:57], v4 offset:14336
    ds_read_b64_tr_b16 a[58:59], v4 offset:15360
    ds_read_b64_tr_b16 a[60:61], v5 offset:14336
    ds_read_b64_tr_b16 a[62:63], v5 offset:15360
    s_waitcnt vmcnt(34)
    ds_read_b64_tr_b16 a[64:65], v4 offset:16384
    ds_read_b64_tr_b16 a[66:67], v4 offset:17408
    ds_read_b64_tr_b16 a[68:69], v5 offset:16384
    ds_read_b64_tr_b16 a[70:71], v5 offset:17408
    s_waitcnt lgkmcnt(4)
    s_add_u32 m0, s58, 12288
    s_add_u32 s59, s57, 479232
    buffer_load_dwordx4 v6, s[24:27], s59 offen offset:0 lds
    buffer_load_dwordx4 v7, s[24:27], s59 offen offset:1024 lds
    buffer_load_dwordx4 v8, s[24:27], s59 offen offset:2048 lds
    buffer_load_dwordx4 v9, s[24:27], s59 offen offset:3072 lds
    s_waitcnt vmcnt(36)
    ds_read_b64_tr_b16 a[72:73], v4 offset:18432
    ds_read_b64_tr_b16 a[74:75], v4 offset:19456
    ds_read_b64_tr_b16 a[76:77], v5 offset:18432
    ds_read_b64_tr_b16 a[78:79], v5 offset:19456
    s_waitcnt vmcnt(34)
    ds_read_b64_tr_b16 a[80:81], v4 offset:20480
    ds_read_b64_tr_b16 a[82:83], v4 offset:21504
    ds_read_b64_tr_b16 a[84:85], v5 offset:20480
    ds_read_b64_tr_b16 a[86:87], v5 offset:21504
    s_waitcnt lgkmcnt(4)
    s_add_u32 m0, s58, 16384
    s_add_u32 s59, s57, 516096
    buffer_load_dwordx4 v6, s[24:27], s59 offen offset:0 lds
    buffer_load_dwordx4 v7, s[24:27], s59 offen offset:1024 lds
    buffer_load_dwordx4 v8, s[24:27], s59 offen offset:2048 lds
    buffer_load_dwordx4 v9, s[24:27], s59 offen offset:3072 lds
    s_waitcnt vmcnt(36)
    ds_read_b64_tr_b16 a[88:89], v4 offset:22528
    ds_read_b64_tr_b16 a[90:91], v4 offset:23552
    ds_read_b64_tr_b16 a[92:93], v5 offset:22528
    ds_read_b64_tr_b16 a[94:95], v5 offset:23552
    s_waitcnt vmcnt(34)
    ds_read_b64_tr_b16 a[96:97], v4 offset:24576
    ds_read_b64_tr_b16 a[98:99], v4 offset:25600
    ds_read_b64_tr_b16 a[100:101], v5 offset:24576
    ds_read_b64_tr_b16 a[102:103], v5 offset:25600
    s_waitcnt lgkmcnt(4)
    s_add_u32 m0, s58, 20480
    s_add_u32 s59, s57, 552960
    buffer_load_dwordx4 v6, s[24:27], s59 offen offset:0 lds
    buffer_load_dwordx4 v7, s[24:27], s59 offen offset:1024 lds
    buffer_load_dwordx4 v8, s[24:27], s59 offen offset:2048 lds
    buffer_load_dwordx4 v9, s[24:27], s59 offen offset:3072 lds
    s_waitcnt vmcnt(36)
    ds_read_b64_tr_b16 a[104:105], v4 offset:26624
    ds_read_b64_tr_b16 a[106:107], v4 offset:27648
    ds_read_b64_tr_b16 a[108:109], v5 offset:26624
    ds_read_b64_tr_b16 a[110:111], v5 offset:27648
    s_waitcnt vmcnt(34)
    ds_read_b64_tr_b16 a[112:113], v4 offset:28672
    ds_read_b64_tr_b16 a[114:115], v4 offset:29696
    ds_read_b64_tr_b16 a[116:117], v5 offset:28672
    ds_read_b64_tr_b16 a[118:119], v5 offset:29696
    s_waitcnt lgkmcnt(4)
    s_add_u32 m0, s58, 24576
    s_add_u32 s59, s57, 589824
    buffer_load_dwordx4 v6, s[24:27], s59 offen offset:0 lds
    buffer_load_dwordx4 v7, s[24:27], s59 offen offset:1024 lds
    buffer_load_dwordx4 v8, s[24:27], s59 offen offset:2048 lds
    buffer_load_dwordx4 v9, s[24:27], s59 offen offset:3072 lds
    s_waitcnt vmcnt(36)
    ds_read_b64_tr_b16 a[120:121], v4 offset:30720
    ds_read_b64_tr_b16 a[122:123], v4 offset:31744
    ds_read_b64_tr_b16 a[124:125], v5 offset:30720
    ds_read_b64_tr_b16 a[126:127], v5 offset:31744
    s_waitcnt vmcnt(34)
    ds_read_b64_tr_b16 a[128:129], v4 offset:32768
    ds_read_b64_tr_b16 a[130:131], v4 offset:33792
    ds_read_b64_tr_b16 a[132:133], v5 offset:32768
    ds_read_b64_tr_b16 a[134:135], v5 offset:33792
    s_waitcnt lgkmcnt(4)
    s_add_u32 m0, s58, 28672
    s_add_u32 s59, s57, 626688
    buffer_load_dwordx4 v6, s[24:27], s59 offen offset:0 lds
    buffer_load_dwordx4 v7, s[24:27], s59 offen offset:1024 lds
    buffer_load_dwordx4 v8, s[24:27], s59 offen offset:2048 lds
    buffer_load_dwordx4 v9, s[24:27], s59 offen offset:3072 lds
    s_waitcnt vmcnt(36)
    ds_read_b64_tr_b16 a[136:137], v4 offset:34816
    ds_read_b64_tr_b16 a[138:139], v4 offset:35840
    ds_read_b64_tr_b16 a[140:141], v5 offset:34816
    ds_read_b64_tr_b16 a[142:143], v5 offset:35840
    s_waitcnt vmcnt(34)
    ds_read_b64_tr_b16 a[144:145], v4 offset:36864
    ds_read_b64_tr_b16 a[146:147], v4 offset:37888
    ds_read_b64_tr_b16 a[148:149], v5 offset:36864
    ds_read_b64_tr_b16 a[150:151], v5 offset:37888
    s_waitcnt lgkmcnt(4)
    s_add_u32 m0, s58, 32768
    s_add_u32 s59, s57, 663552
    buffer_load_dwordx4 v6, s[24:27], s59 offen offset:0 lds
    buffer_load_dwordx4 v7, s[24:27], s59 offen offset:1024 lds
    buffer_load_dwordx4 v8, s[24:27], s59 offen offset:2048 lds
    buffer_load_dwordx4 v9, s[24:27], s59 offen offset:3072 lds
    s_waitcnt vmcnt(36)
    ds_read_b64_tr_b16 a[152:153], v4 offset:38912
    ds_read_b64_tr_b16 a[154:155], v4 offset:39936
    ds_read_b64_tr_b16 a[156:157], v5 offset:38912
    ds_read_b64_tr_b16 a[158:159], v5 offset:39936
    s_waitcnt vmcnt(34)
    ds_read_b64_tr_b16 a[160:161], v4 offset:0
    ds_read_b64_tr_b16 a[162:163], v4 offset:1024
    ds_read_b64_tr_b16 a[164:165], v5 offset:0
    ds_read_b64_tr_b16 a[166:167], v5 offset:1024
    s_waitcnt lgkmcnt(4)
    s_add_u32 m0, s58, 36864
    s_add_u32 s59, s57, 700416
    buffer_load_dwordx4 v6, s[24:27], s59 offen offset:0 lds
    buffer_load_dwordx4 v7, s[24:27], s59 offen offset:1024 lds
    buffer_load_dwordx4 v8, s[24:27], s59 offen offset:2048 lds
    buffer_load_dwordx4 v9, s[24:27], s59 offen offset:3072 lds
    s_waitcnt vmcnt(36)
    ds_read_b64_tr_b16 a[168:169], v4 offset:2048
    ds_read_b64_tr_b16 a[170:171], v4 offset:3072
    ds_read_b64_tr_b16 a[172:173], v5 offset:2048
    ds_read_b64_tr_b16 a[174:175], v5 offset:3072
    s_waitcnt vmcnt(34)
    ds_read_b64_tr_b16 a[176:177], v4 offset:4096
    ds_read_b64_tr_b16 a[178:179], v4 offset:5120
    ds_read_b64_tr_b16 a[180:181], v5 offset:4096
    ds_read_b64_tr_b16 a[182:183], v5 offset:5120
    s_waitcnt lgkmcnt(4)
    s_add_u32 m0, s58, 0
    s_add_u32 s59, s57, 737280
    buffer_load_dwordx4 v6, s[24:27], s59 offen offset:0 lds
    buffer_load_dwordx4 v7, s[24:27], s59 offen offset:1024 lds
    buffer_load_dwordx4 v8, s[24:27], s59 offen offset:2048 lds
    buffer_load_dwordx4 v9, s[24:27], s59 offen offset:3072 lds
    s_waitcnt vmcnt(36)
    ds_read_b64_tr_b16 a[184:185], v4 offset:6144
    ds_read_b64_tr_b16 a[186:187], v4 offset:7168
    ds_read_b64_tr_b16 a[188:189], v5 offset:6144
    ds_read_b64_tr_b16 a[190:191], v5 offset:7168
    s_waitcnt vmcnt(34)
    ds_read_b64_tr_b16 a[192:193], v4 offset:8192
    ds_read_b64_tr_b16 a[194:195], v4 offset:9216
    ds_read_b64_tr_b16 a[196:197], v5 offset:8192
    ds_read_b64_tr_b16 a[198:199], v5 offset:9216
    s_waitcnt lgkmcnt(4)
    s_add_u32 m0, s58, 4096
    s_add_u32 s59, s57, 774144
    buffer_load_dwordx4 v6, s[24:27], s59 offen offset:0 lds
    buffer_load_dwordx4 v7, s[24:27], s59 offen offset:1024 lds
    buffer_load_dwordx4 v8, s[24:27], s59 offen offset:2048 lds
    buffer_load_dwordx4 v9, s[24:27], s59 offen offset:3072 lds
    s_waitcnt vmcnt(36)
    ds_read_b64_tr_b16 a[200:201], v4 offset:10240
    ds_read_b64_tr_b16 a[202:203], v4 offset:11264
    ds_read_b64_tr_b16 a[204:205], v5 offset:10240
    ds_read_b64_tr_b16 a[206:207], v5 offset:11264
    s_waitcnt vmcnt(34)
    ds_read_b64_tr_b16 a[208:209], v4 offset:12288
    ds_read_b64_tr_b16 a[210:211], v4 offset:13312
    ds_read_b64_tr_b16 a[212:213], v5 offset:12288
    ds_read_b64_tr_b16 a[214:215], v5 offset:13312
    s_waitcnt lgkmcnt(4)
    s_add_u32 m0, s58, 8192
    s_add_u32 s59, s57, 811008
    buffer_load_dwordx4 v6, s[24:27], s59 offen offset:0 lds
    buffer_load_dwordx4 v7, s[24:27], s59 offen offset:1024 lds
    buffer_load_dwordx4 v8, s[24:27], s59 offen offset:2048 lds
    buffer_load_dwordx4 v9, s[24:27], s59 offen offset:3072 lds
    s_waitcnt vmcnt(36)
    ds_read_b64_tr_b16 a[216:217], v4 offset:14336
    ds_read_b64_tr_b16 a[218:219], v4 offset:15360
    ds_read_b64_tr_b16 a[220:221], v5 offset:14336
    ds_read_b64_tr_b16 a[222:223], v5 offset:15360
    buffer_load_dword v10, off, s[36:39], s92 sc1
    buffer_load_dword v11, off, s[36:39], s93 sc1
    s_waitcnt vmcnt(36)
    ds_read_b64_tr_b16 a[224:225], v4 offset:16384
    ds_read_b64_tr_b16 a[226:227], v4 offset:17408
    ds_read_b64_tr_b16 a[228:229], v5 offset:16384
    ds_read_b64_tr_b16 a[230:231], v5 offset:17408
    s_waitcnt lgkmcnt(4)
    s_add_u32 m0, s58, 12288
    s_add_u32 s59, s57, 847872
    buffer_load_dwordx4 v6, s[24:27], s59 offen offset:0 lds
    buffer_load_dwordx4 v7, s[24:27], s59 offen offset:1024 lds
    buffer_load_dwordx4 v8, s[24:27], s59 offen offset:2048 lds
    buffer_load_dwordx4 v9, s[24:27], s59 offen offset:3072 lds
    s_waitcnt vmcnt(38)
    ds_read_b64_tr_b16 a[232:233], v4 offset:18432
    ds_read_b64_tr_b16 a[234:235], v4 offset:19456
    ds_read_b64_tr_b16 a[236:237], v5 offset:18432
    ds_read_b64_tr_b16 a[238:239], v5 offset:19456
    s_waitcnt vmcnt(36)
    ds_read_b64_tr_b16 a[240:241], v4 offset:20480
    ds_read_b64_tr_b16 a[242:243], v4 offset:21504
    ds_read_b64_tr_b16 a[244:245], v5 offset:20480
    ds_read_b64_tr_b16 a[246:247], v5 offset:21504
    s_waitcnt lgkmcnt(4)
    s_add_u32 m0, s58, 16384
    s_add_u32 s59, s57, 884736
    buffer_load_dwordx4 v6, s[24:27], s59 offen offset:0 lds
    buffer_load_dwordx4 v7, s[24:27], s59 offen offset:1024 lds
    buffer_load_dwordx4 v8, s[24:27], s59 offen offset:2048 lds
    buffer_load_dwordx4 v9, s[24:27], s59 offen offset:3072 lds
    s_waitcnt vmcnt(38)
    ds_read_b64_tr_b16 a[248:249], v4 offset:22528
    ds_read_b64_tr_b16 a[250:251], v4 offset:23552
    ds_read_b64_tr_b16 a[252:253], v5 offset:22528
    ds_read_b64_tr_b16 a[254:255], v5 offset:23552
    s_waitcnt vmcnt(36)
    ds_read_b64_tr_b16 v[160:161], v4 offset:24576
    ds_read_b64_tr_b16 v[162:163], v4 offset:25600
    ds_read_b64_tr_b16 v[164:165], v5 offset:24576
    ds_read_b64_tr_b16 v[166:167], v5 offset:25600
    s_waitcnt lgkmcnt(4)
    s_add_u32 m0, s58, 20480
    s_add_u32 s59, s57, 921600
    buffer_load_dwordx4 v6, s[24:27], s59 offen offset:0 lds
    buffer_load_dwordx4 v7, s[24:27], s59 offen offset:1024 lds
    buffer_load_dwordx4 v8, s[24:27], s59 offen offset:2048 lds
    buffer_load_dwordx4 v9, s[24:27], s59 offen offset:3072 lds
    s_waitcnt vmcnt(38)
    ds_read_b64_tr_b16 v[168:169], v4 offset:26624
    ds_read_b64_tr_b16 v[170:171], v4 offset:27648
    ds_read_b64_tr_b16 v[172:173], v5 offset:26624
    ds_read_b64_tr_b16 v[174:175], v5 offset:27648
    s_waitcnt vmcnt(12)
    v_min_u32 v10, v10, v11
    s_nop 0
    v_readfirstlane_b32 s3, v10
    s_cmp_ge_u32 s3, 4
    s_cbranch_scc0 L_poll
L_go:
    s_mov_b32 s56, 40960
    buffer_load_dwordx4 v[80:83], v14, s[28:31], s56 offen offset:2048 sc1
    buffer_load_dwordx4 v[84:87], v15, s[28:31], s56 offen offset:2048 sc1
    buffer_load_dwordx4 v[88:91], v14, s[28:31], s56 offen offset:3072 sc1
    buffer_load_dwordx4 v[92:95], v15, s[28:31], s56 offen offset:3072 sc1
    s_mov_b32 s56, 45056
    buffer_load_dwordx4 v[96:99], v14, s[28:31], s56 offen offset:0 sc1
    buffer_load_dwordx4 v[100:103], v15, s[28:31], s56 offen offset:0 sc1
    buffer_load_dwordx4 v[104:107], v14, s[28:31], s56 offen offset:1024 sc1
    buffer_load_dwordx4 v[108:111], v15, s[28:31], s56 offen offset:1024 sc1
    buffer_load_dwordx4 v[112:115], v14, s[28:31], s56 offen offset:2048 sc1
    buffer_load_dwordx4 v[116:119], v15, s[28:31], s56 offen offset:2048 sc1
    buffer_load_dwordx4 v[120:123], v14, s[28:31], s56 offen offset:3072 sc1
    buffer_load_dwordx4 v[124:127], v15, s[28:31], s56 offen offset:3072 sc1
    s_mov_b32 s56, 49152
    buffer_load_dwordx4 v[128:131], v14, s[28:31], s56 offen offset:0 sc1
    buffer_load_dwordx4 v[132:135], v15, s[28:31], s56 offen offset:0 sc1
    buffer_load_dwordx4 v[136:139], v14, s[28:31], s56 offen offset:1024 sc1
    buffer_load_dwordx4 v[140:143], v15, s[28:31], s56 offen offset:1024 sc1
    s_waitcnt vmcnt(52)
    ds_read_b64_tr_b16 v[176:177], v4 offset:28672
    ds_read_b64_tr_b16 v[178:179], v4 offset:29696
    ds_read_b64_tr_b16 v[180:181], v5 offset:28672
    ds_read_b64_tr_b16 v[182:183], v5 offset:29696
    s_waitcnt lgkmcnt(4)
    s_add_u32 m0, s58, 24576
    s_add_u32 s59, s57, 958464
    buffer_load_dwordx4 v6, s[24:27], s59 offen offset:0 lds
    buffer_load_dwordx4 v7, s[24:27], s59 offen offset:1024 lds
    buffer_load_dwordx4 v8, s[24:27], s59 offen offset:2048 lds
    buffer_load_dwordx4 v9, s[24:27], s59 offen offset:3072 lds
    s_waitcnt vmcnt(54)
    ds_read_b64_tr_b16 v[184:185], v4 offset:30720
    ds_read_b64_tr_b16 v[186:187], v4 offset:31744
    ds_read_b64_tr_b16 v[188:189], v5 offset:30720
    ds_read_b64_tr_b16 v[190:191], v5 offset:31744
    s_waitcnt vmcnt(52)
    ds_read_b64_tr_b16 v[192:193], v4 offset:32768
    ds_read_b64_tr_b16 v[194:195], v4 offset:33792
    ds_read_b64_tr_b16 v[196:197], v5 offset:32768
    ds_read_b64_tr_b16 v[198:199], v5 offset:33792
    s_waitcnt lgkmcnt(4)
    s_add_u32 m0, s58, 28672
    s_add_u32 s59, s57, 995328
    buffer_load_dwordx4 v6, s[24:27], s59 offen offset:0 lds
    buffer_load_dwordx4 v7, s[24:27], s59 offen offset:1024 lds
    buffer_load_dwordx4 v8, s[24:27], s59 offen offset:2048 lds
    buffer_load_dwordx4 v9, s[24:27], s59 offen offset:3072 lds
    s_waitcnt vmcnt(54)
    ds_read_b64_tr_b16 v[200:201], v4 offset:34816
    ds_read_b64_tr_b16 v[202:203], v4 offset:35840
    ds_read_b64_tr_b16 v[204:205], v5 offset:34816
    ds_read_b64_tr_b16 v[206:207], v5 offset:35840
    s_waitcnt vmcnt(52)
    ds_read_b64_tr_b16 v[208:209], v4 offset:36864
    ds_read_b64_tr_b16 v[210:211], v4 offset:37888
    ds_read_b64_tr_b16 v[212:213], v5 offset:36864
    ds_read_b64_tr_b16 v[214:215], v5 offset:37888
    s_waitcnt lgkmcnt(4)
    s_add_u32 m0, s58, 32768
    s_add_u32 s59, s57, 1032192
    buffer_load_dwordx4 v6, s[24:27], s59 offen offset:0 lds
    buffer_load_dwordx4 v7, s[24:27], s59 offen offset:1024 lds
    buffer_load_dwordx4 v8, s[24:27], s59 offen offset:2048 lds
    buffer_load_dwordx4 v9, s[24:27], s59 offen offset:3072 lds
    s_waitcnt vmcnt(54)
    ds_read_b64_tr_b16 v[216:217], v4 offset:38912
    ds_read_b64_tr_b16 v[218:219], v4 offset:39936
    ds_read_b64_tr_b16 v[220:221], v5 offset:38912
    ds_read_b64_tr_b16 v[222:223], v5 offset:39936
    s_waitcnt vmcnt(52)
    ds_read_b64_tr_b16 v[224:225], v4 offset:0
    ds_read_b64_tr_b16 v[226:227], v4 offset:1024
    ds_read_b64_tr_b16 v[228:229], v5 offset:0
    ds_read_b64_tr_b16 v[230:231], v5 offset:1024
    s_waitcnt lgkmcnt(4)
    s_add_u32 m0, s58, 36864
    s_add_u32 s59, s57, 1069056
    buffer_load_dwordx4 v6, s[24:27], s59 offen offset:0 lds
    buffer_load_dwordx4 v7, s[24:27], s59 offen offset:1024 lds
    buffer_load_dwordx4 v8, s[24:27], s59 offen offset:2048 lds
    buffer_load_dwordx4 v9, s[24:27], s59 offen offset:3072 lds
    s_waitcnt vmcnt(54)
    ds_read_b64_tr_b16 v[232:233], v4 offset:2048
    ds_read_b64_tr_b16 v[234:235], v4 offset:3072
    ds_read_b64_tr_b16 v[236:237], v5 offset:2048
    ds_read_b64_tr_b16 v[238:239], v5 offset:3072
    s_waitcnt lgkmcnt(0)
    s_add_u32 m0, s58, 0
    s_add_u32 s59, s57, 1105920
    buffer_load_dwordx4 v6, s[24:27], s59 offen offset:0 lds
    buffer_load_dwordx4 v7, s[24:27], s59 offen offset:1024 lds
    buffer_load_dwordx4 v8, s[24:27], s59 offen offset:2048 lds
    buffer_load_dwordx4 v9, s[24:27], s59 offen offset:3072 lds
    s_waitcnt vmcnt(56)
    ds_read_b64_tr_b16 v[144:145], v4 offset:4096
    ds_read_b64_tr_b16 v[146:147], v4 offset:5120
    ds_read_b64_tr_b16 v[148:149], v5 offset:4096
    ds_read_b64_tr_b16 v[150:151], v5 offset:5120
    s_waitcnt vmcnt(35) lgkmcnt(2)
    v_mfma_f32_32x32x16_bf16 v[16:31], v[144:147], v[80:83], 0
    s_waitcnt vmcnt(54)
    ds_read_b64_tr_b16 v[152:153], v4 offset:6144
    ds_read_b64_tr_b16 v[154:155], v4 offset:7168
    ds_read_b64_tr_b16 v[156:157], v5 offset:6144
    ds_read_b64_tr_b16 v[158:159], v5 offset:7168
    s_waitcnt lgkmcnt(4)
    v_mfma_f32_32x32x16_bf16 v[48:63], v[148:151], v[80:83], 0
    buffer_load_dwordx4 v[80:83], v14, s[28:31], s56 offen offset:2048 sc1
    s_waitcnt vmcnt(35)
    v_mfma_f32_32x32x16_bf16 v[32:47], v[144:147], v[84:87], 0
    v_mfma_f32_32x32x16_bf16 v[64:79], v[148:151], v[84:87], 0
    buffer_load_dwordx4 v[84:87], v15, s[28:31], s56 offen offset:2048 sc1
    s_waitcnt vmcnt(35) lgkmcnt(2)
    v_mfma_f32_32x32x16_bf16 v[16:31], v[152:155], v[88:91], v[16:31]
    s_waitcnt vmcnt(54)
    ds_read_b64_tr_b16 v[144:145], v4 offset:8192
    ds_read_b64_tr_b16 v[146:147], v4 offset:9216
    ds_read_b64_tr_b16 v[148:149], v5 offset:8192
    ds_read_b64_tr_b16 v[150:151], v5 offset:9216
    s_waitcnt lgkmcnt(4)
    v_mfma_f32_32x32x16_bf16 v[48:63], v[156:159], v[88:91], v[48:63]
    buffer_load_dwordx4 v[88:91], v14, s[28:31], s56 offen offset:3072 sc1
    s_waitcnt vmcnt(35)
    v_mfma_f32_32x32x16_bf16 v[32:47], v[152:155], v[92:95], v[32:47]
    s_add_u32 m0, s58, 4096
    s_add_u32 s59, s57, 1142784
    buffer_load_dwordx4 v6, s[24:27], s59 offen offset:0 lds
    buffer_load_dwordx4 v7, s[24:27], s59 offen offset:1024 lds
    buffer_load_dwordx4 v8, s[24:27], s59 offen offset:2048 lds
    buffer_load_dwordx4 v9, s[24:27], s59 offen offset:3072 lds
    v_mfma_f32_32x32x16_bf16 v[64:79], v[156:159], v[92:95], v[64:79]
    buffer_load_dwordx4 v[92:95], v15, s[28:31], s56 offen offset:3072 sc1
    s_waitcnt vmcnt(39) lgkmcnt(2)
    v_mfma_f32_32x32x16_bf16 v[16:31], v[144:147], v[96:99], v[16:31]
    s_waitcnt vmcnt(58)
    ds_read_b64_tr_b16 v[152:153], v4 offset:10240
    ds_read_b64_tr_b16 v[154:155], v4 offset:11264
    ds_read_b64_tr_b16 v[156:157], v5 offset:10240
    ds_read_b64_tr_b16 v[158:159], v5 offset:11264
    s_waitcnt lgkmcnt(4)
    v_mfma_f32_32x32x16_bf16 v[48:63], v[148:151], v[96:99], v[48:63]
    s_mov_b32 s56, 53248
    buffer_load_dwordx4 v[96:99], v14, s[28:31], s56 offen offset:0 sc1
    s_waitcnt vmcnt(39)
    v_mfma_f32_32x32x16_bf16 v[32:47], v[144:147], v[100:103], v[32:47]
    v_mfma_f32_32x32x16_bf16 v[64:79], v[148:151], v[100:103], v[64:79]
    buffer_load_dwordx4 v[100:103], v15, s[28:31], s56 offen offset:0 sc1
    s_waitcnt vmcnt(39) lgkmcnt(2)
    v_mfma_f32_32x32x16_bf16 v[16:31], v[152:155], v[104:107], v[16:31]
    s_waitcnt vmcnt(56)
    ds_read_b64_tr_b16 v[144:145], v4 offset:12288
    ds_read_b64_tr_b16 v[146:147], v4 offset:13312
    ds_read_b64_tr_b16 v[148:149], v5 offset:12288
    ds_read_b64_tr_b16 v[150:151], v5 offset:13312
    s_waitcnt lgkmcnt(4)
    v_mfma_f32_32x32x16_bf16 v[48:63], v[156:159], v[104:107], v[48:63]
    buffer_load_dwordx4 v[104:107], v14, s[28:31], s56 offen offset:1024 sc1
    s_waitcnt vmcnt(39)
    v_mfma_f32_32x32x16_bf16 v[32:47], v[152:155], v[108:111], v[32:47]
    v_mfma_f32_32x32x16_bf16 v[64:79], v[156:159], v[108:111], v[64:79]
    buffer_load_dwordx4 v[108:111], v15, s[28:31], s56 offen offset:1024 sc1
    s_waitcnt vmcnt(39) lgkmcnt(2)
    v_mfma_f32_32x32x16_bf16 v[16:31], v[144:147], v[112:115], v[16:31]
    s_waitcnt vmcnt(56)
    ds_read_b64_tr_b16 v[152:153], v4 offset:14336
    ds_read_b64_tr_b16 v[154:155], v4 offset:15360
    ds_read_b64_tr_b16 v[156:157], v5 offset:14336
    ds_read_b64_tr_b16 v[158:159], v5 offset:15360
    s_waitcnt lgkmcnt(4)
    v_mfma_f32_32x32x16_bf16 v[48:63], v[148:151], v[112:115], v[48:63]
    buffer_load_dwordx4 v[112:115], v14, s[28:31], s56 offen offset:2048 sc1
    s_waitcnt vmcnt(39)
    v_mfma_f32_32x32x16_bf16 v[32:47], v[144:147], v[116:119], v[32:47]
    v_mfma_f32_32x32x16_bf16 v[64:79], v[148:151], v[116:119], v[64:79]
    buffer_load_dwordx4 v[116:119], v15, s[28:31], s56 offen offset:2048 sc1
    s_waitcnt vmcnt(39) lgkmcnt(2)
    v_mfma_f32_32x32x16_bf16 v[16:31], v[152:155], v[120:123], v[16:31]
    s_waitcnt vmcnt(56)
    ds_read_b64_tr_b16 v[144:145], v4 offset:16384
    ds_read_b64_tr_b16 v[146:147], v4 offset:17408
    ds_read_b64_tr_b16 v[148:149], v5 offset:16384
    ds_read_b64_tr_b16 v[150:151], v5 offset:17408
    s_waitcnt lgkmcnt(4)
    v_mfma_f32_32x32x16_bf16 v[48:63], v[156:159], v[120:123], v[48:63]
    buffer_load_dwordx4 v[120:123], v14, s[28:31], s56 offen offset:3072 sc1
    s_waitcnt vmcnt(39)
    v_mfma_f32_32x32x16_bf16 v[32:47], v[152:155], v[124:127], v[32:47]
    v_mfma_f32_32x32x16_bf16 v[64:79], v[156:159], v[124:127], v[64:79]
    buffer_load_dwordx4 v[124:127], v15, s[28:31], s56 offen offset:3072 sc1
    s_waitcnt vmcnt(39) lgkmcnt(2)
    v_mfma_f32_32x32x16_bf16 v[16:31], v[144:147], v[128:131], v[16:31]
    s_waitcnt vmcnt(56)
    ds_read_b64_tr_b16 v[152:153], v4 offset:18432
    ds_read_b64_tr_b16 v[154:155], v4 offset:19456
    ds_read_b64_tr_b16 v[156:157], v5 offset:18432
    ds_read_b64_tr_b16 v[158:159], v5 offset:19456
    s_waitcnt lgkmcnt(4)
    v_mfma_f32_32x32x16_bf16 v[48:63], v[148:151], v[128:131], v[48:63]
    s_mov_b32 s56, 57344
    buffer_load_dwordx4 v[128:131], v14, s[28:31], s56 offen offset:0 sc1
    s_waitcnt vmcnt(39)
    v_mfma_f32_32x32x16_bf16 v[32:47], v[144:147], v[132:135], v[32:47]
    v_mfma_f32_32x32x16_bf16 v[64:79], v[148:151], v[132:135], v[64:79]
    buffer_load_dwordx4 v[132:135], v15, s[28:31], s56 offen offset:0 sc1
    s_waitcnt vmcnt(39) lgkmcnt(2)
    v_mfma_f32_32x32x16_bf16 v[16:31], v[152:155], v[136:139], v[16:31]
    s_waitcnt vmcnt(56)
    ds_read_b64_tr_b16 v[144:145], v4 offset:20480
    ds_read_b64_tr_b16 v[146:147], v4 offset:21504
    ds_read_b64_tr_b16 v[148:149], v5 offset:20480
    ds_read_b64_tr_b16 v[150:151], v5 offset:21504
    s_waitcnt lgkmcnt(4)
    v_mfma_f32_32x32x16_bf16 v[48:63], v[156:159], v[136:139], v[48:63]
    buffer_load_dwordx4 v[136:139], v14, s[28:31], s56 offen offset:1024 sc1
    s_waitcnt vmcnt(39)
    v_mfma_f32_32x32x16_bf16 v[32:47], v[152:155], v[140:143], v[32:47]
    v_mfma_f32_32x32x16_bf16 v[64:79], v[156:159], v[140:143], v[64:79]
    buffer_load_dwordx4 v[140:143], v15, s[28:31], s56 offen offset:1024 sc1
    s_waitcnt vmcnt(19) lgkmcnt(2)
    v_mfma_f32_32x32x16_bf16 v[16:31], v[144:147], v[80:83], v[16:31]
    s_waitcnt vmcnt(56)
    ds_read_b64_tr_b16 v[152:153], v4 offset:22528
    ds_read_b64_tr_b16 v[154:155], v4 offset:23552
    ds_read_b64_tr_b16 v[156:157], v5 offset:22528
    ds_read_b64_tr_b16 v[158:159], v5 offset:23552
    s_waitcnt lgkmcnt(4)
    v_mfma_f32_32x32x16_bf16 v[48:63], v[148:151], v[80:83], v[48:63]
    buffer_load_dwordx4 v[80:83], v14, s[28:31], s56 offen offset:2048 sc1
    s_waitcnt vmcnt(19)
    v_mfma_f32_32x32x16_bf16 v[32:47], v[144:147], v[84:87], v[32:47]
    v_mfma_f32_32x32x16_bf16 v[64:79], v[148:151], v[84:87], v[64:79]
    buffer_load_dwordx4 v[84:87], v15, s[28:31], s56 offen offset:2048 sc1
    s_waitcnt vmcnt(19) lgkmcnt(2)
    v_mfma_f32_32x32x16_bf16 v[16:31], v[152:155], v[88:91], v[16:31]
    s_waitcnt vmcnt(40)
    ds_read_b64_tr_b16 v[144:145], v4 offset:24576
    ds_read_b64_tr_b16 v[146:147], v4 offset:25600
    ds_read_b64_tr_b16 v[148:149], v5 offset:24576
    ds_read_b64_tr_b16 v[150:151], v5 offset:25600
    s_waitcnt lgkmcnt(4)
    v_mfma_f32_32x32x16_bf16 v[48:63], v[156:159], v[88:91], v[48:63]
    buffer_load_dwordx4 v[88:91], v14, s[28:31], s56 offen offset:3072 sc1
    s_waitcnt vmcnt(15)
    v_mfma_f32_32x32x16_bf16 v[32:47], v[152:155], v[92:95], v[32:47]
    v_mfma_f32_32x32x16_bf16 v[64:79], v[156:159], v[92:95], v[64:79]
    buffer_load_dwordx4 v[92:95], v15, s[28:31], s56 offen offset:3072 sc1
    s_waitcnt vmcnt(15) lgkmcnt(2)
    v_mfma_f32_32x32x16_bf16 v[16:31], v[144:147], v[96:99], v[16:31]
    s_waitcnt vmcnt(40)
    ds_read_b64_tr_b16 v[152:153], v4 offset:26624
    ds_read_b64_tr_b16 v[154:155], v4 offset:27648
    ds_read_b64_tr_b16 v[156:157], v5 offset:26624
    ds_read_b64_tr_b16 v[158:159], v5 offset:27648
    s_waitcnt lgkmcnt(4)
    v_mfma_f32_32x32x16_bf16 v[48:63], v[148:151], v[96:99], v[48:63]
    s_mov_b32 s56, 61440
    buffer_load_dwordx4 v[96:99], v14, s[28:31], s56 offen offset:0 sc1
    s_waitcnt vmcnt(15)
    v_mfma_f32_32x32x16_bf16 v[32:47], v[144:147], v[100:103], v[32:47]
    v_mfma_f32_32x32x16_bf16 v[64:79], v[148:151], v[100:103], v[64:79]
    buffer_load_dwordx4 v[100:103], v15, s[28:31], s56 offen offset:0 sc1
    s_waitcnt vmcnt(15) lgkmcnt(2)
    v_mfma_f32_32x32x16_bf16 v[16:31], v[152:155], v[104:107], v[16:31]
    s_waitcnt vmcnt(40)
    ds_read_b64_tr_b16 v[144:145], v4 offset:28672
    ds_read_b64_tr_b16 v[146:147], v4 offset:29696
    ds_read_b64_tr_b16 v[148:149], v5 offset:28672
    ds_read_b64_tr_b16 v[150:151], v5 offset:29696
    s_waitcnt lgkmcnt(4)
    v_mfma_f32_32x32x16_bf16 v[48:63], v[156:159], v[104:107], v[48:63]
    buffer_load_dwordx4 v[104:107], v14, s[28:31], s56 offen offset:1024 sc1
    s_waitcnt vmcnt(15)
    v_mfma_f32_32x32x16_bf16 v[32:47], v[152:155], v[108:111], v[32:47]
    v_mfma_f32_32x32x16_bf16 v[64:79], v[156:159], v[108:111], v[64:79]
    buffer_load_dwordx4 v[108:111], v15, s[28:31], s56 offen offset:1024 sc1
    s_waitcnt vmcnt(15) lgkmcnt(2)
    v_mfma_f32_32x32x16_bf16 v[16:31], v[144:147], v[112:115], v[16:31]
    s_waitcnt vmcnt(40)
    ds_read_b64_tr_b16 v[152:153], v4 offset:30720
    ds_read_b64_tr_b16 v[154:155], v4 offset:31744
    ds_read_b64_tr_b16 v[156:157], v5 offset:30720
    ds_read_b64_tr_b16 v[158:159], v5 offset:31744
    s_waitcnt lgkmcnt(4)
    v_mfma_f32_32x32x16_bf16 v[48:63], v[148:151], v[112:115], v[48:63]
    s_mov_b32 s56, 0
    buffer_load_dwordx4 v[112:115], v14, s[28:31], s56 offen offset:0 sc1
    s_waitcnt vmcnt(15)
    v_mfma_f32_32x32x16_bf16 v[32:47], v[144:147], v[116:119], v[32:47]
    v_mfma_f32_32x32x16_bf16 v[64:79], v[148:151], v[116:119], v[64:79]
    buffer_load_dwordx4 v[116:119], v15, s[28:31], s56 offen offset:0 sc1
    s_waitcnt vmcnt(15) lgkmcnt(2)
    v_mfma_f32_32x32x16_bf16 v[16:31], v[152:155], v[120:123], v[16:31]
    s_waitcnt vmcnt(40)
    ds_read_b64_tr_b16 v[144:145], v4 offset:32768
    ds_read_b64_tr_b16 v[146:147], v4 offset:33792
    ds_read_b64_tr_b16 v[148:149], v5 offset:32768
    ds_read_b64_tr_b16 v[150:151], v5 offset:33792
    s_waitcnt lgkmcnt(4)
    v_mfma_f32_32x32x16_bf16 v[48:63], v[156:159], v[120:123], v[48:63]
    buffer_load_dwordx4 v[120:123], v14, s[28:31], s56 offen offset:1024 sc1
    s_waitcnt vmcnt(15)
    v_mfma_f32_32x32x16_bf16 v[32:47], v[152:155], v[124:127], v[32:47]
    v_mfma_f32_32x32x16_bf16 v[64:79], v[156:159], v[124:127], v[64:79]
    buffer_load_dwordx4 v[124:127], v15, s[28:31], s56 offen offset:1024 sc1
    s_waitcnt vmcnt(15) lgkmcnt(2)
    v_mfma_f32_32x32x16_bf16 v[16:31], v[144:147], v[128:131], v[16:31]
    s_waitcnt vmcnt(40)
    ds_read_b64_tr_b16 v[152:153], v4 offset:34816
    ds_read_b64_tr_b16 v[154:155], v4 offset:35840
    ds_read_b64_tr_b16 v[156:157], v5 offset:34816
    ds_read_b64_tr_b16 v[158:159], v5 offset:35840
    s_waitcnt lgkmcnt(4)
    v_mfma_f32_32x32x16_bf16 v[48:63], v[148:151], v[128:131], v[48:63]
    buffer_load_dwordx4 v[128:131], v14, s[28:31], s56 offen offset:2048 sc1
    s_waitcnt vmcnt(15)
    v_mfma_f32_32x32x16_bf16 v[32:47], v[144:147], v[132:135], v[32:47]
    v_mfma_f32_32x32x16_bf16 v[64:79], v[148:151], v[132:135], v[64:79]
    buffer_load_dwordx4 v[132:135], v15, s[28:31], s56 offen offset:2048 sc1
    s_waitcnt vmcnt(15) lgkmcnt(2)
    v_mfma_f32_32x32x16_bf16 v[16:31], v[152:155], v[136:139], v[16:31]
    s_waitcnt vmcnt(40)
    ds_read_b64_tr_b16 v[144:145], v4 offset:36864
    ds_read_b64_tr_b16 v[146:147], v4 offset:37888
    ds_read_b64_tr_b16 v[148:149], v5 offset:36864
    ds_read_b64_tr_b16 v[150:151], v5 offset:37888
    s_waitcnt lgkmcnt(4)
    v_mfma_f32_32x32x16_bf16 v[48:63], v[156:159], v[136:139], v[48:63]
    buffer_load_dwordx4 v[136:139], v14, s[28:31], s56 offen offset:3072 sc1
    s_waitcnt vmcnt(15)
    v_mfma_f32_32x32x16_bf16 v[32:47], v[152:155], v[140:143], v[32:47]
    v_mfma_f32_32x32x16_bf16 v[64:79], v[156:159], v[140:143], v[64:79]
    buffer_load_dwordx4 v[140:143], v15, s[28:31], s56 offen offset:3072 sc1
    s_waitcnt vmcnt(15) lgkmcnt(2)
    v_mfma_f32_32x32x16_bf16 v[16:31], v[144:147], v[80:83], v[16:31]
    s_waitcnt vmcnt(40)
    ds_read_b64_tr_b16 v[152:153], v4 offset:38912
    ds_read_b64_tr_b16 v[154:155], v4 offset:39936
    ds_read_b64_tr_b16 v[156:157], v5 offset:38912
    ds_read_b64_tr_b16 v[158:159], v5 offset:39936
    s_waitcnt lgkmcnt(4)
    v_mfma_f32_32x32x16_bf16 v[48:63], v[148:151], v[80:83], v[48:63]
    s_mov_b32 s56, 4096
    buffer_load_dwordx4 v[80:83], v14, s[28:31], s56 offen offset:0 sc1
    s_waitcnt vmcnt(15)
    v_mfma_f32_32x32x16_bf16 v[32:47], v[144:147], v[84:87], v[32:47]
    v_mfma_f32_32x32x16_bf16 v[64:79], v[148:151], v[84:87], v[64:79]
    buffer_load_dwordx4 v[84:87], v15, s[28:31], s56 offen offset:0 sc1
    s_waitcnt vmcnt(15) lgkmcnt(2)
    v_mfma_f32_32x32x16_bf16 v[16:31], v[152:155], v[88:91], v[16:31]
    s_waitcnt vmcnt(40)
    ds_read_b64_tr_b16 v[144:145], v4 offset:0
    ds_read_b64_tr_b16 v[146:147], v4 offset:1024
    ds_read_b64_tr_b16 v[148:149], v5 offset:0
    ds_read_b64_tr_b16 v[150:151], v5 offset:1024
    s_waitcnt lgkmcnt(4)
    v_mfma_f32_32x32x16_bf16 v[48:63], v[156:159], v[88:91], v[48:63]
    buffer_load_dwordx4 v[88:91], v14, s[28:31], s56 offen offset:1024 sc1
    s_waitcnt vmcnt(15)
    v_mfma_f32_32x32x16_bf16 v[32:47], v[152:155], v[92:95], v[32:47]
    v_mfma_f32_32x32x16_bf16 v[64:79], v[156:159], v[92:95], v[64:79]
    buffer_load_dwordx4 v[92:95], v15, s[28:31], s56 offen offset:1024 sc1
    s_waitcnt vmcnt(15) lgkmcnt(2)
    v_mfma_f32_32x32x16_bf16 v[16:31], v[144:147], v[96:99], v[16:31]
    s_waitcnt vmcnt(40)
    ds_read_b64_tr_b16 v[152:153], v4 offset:2048
    ds_read_b64_tr_b16 v[154:155], v4 offset:3072
    ds_read_b64_tr_b16 v[156:157], v5 offset:2048
    ds_read_b64_tr_b16 v[158:159], v5 offset:3072
    s_waitcnt lgkmcnt(4)
    v_mfma_f32_32x32x16_bf16 v[48:63], v[148:151], v[96:99], v[48:63]
    buffer_load_dwordx4 v[96:99], v14, s[28:31], s56 offen offset:2048 sc1
    s_waitcnt vmcnt(15)
    v_mfma_f32_32x32x16_bf16 v[32:47], v[144:147], v[100:103], v[32:47]
    v_mfma_f32_32x32x16_bf16 v[64:79], v[148:151], v[100:103], v[64:79]
    buffer_load_dwordx4 v[100:103], v15, s[28:31], s56 offen offset:2048 sc1
    s_waitcnt vmcnt(15) lgkmcnt(2)
    v_mfma_f32_32x32x16_bf16 v[16:31], v[152:155], v[104:107], v[16:31]
    s_waitcnt lgkmcnt(0)
    v_mfma_f32_32x32x16_bf16 v[48:63], v[156:159], v[104:107], v[48:63]
    buffer_load_dwordx4 v[104:107], v14, s[28:31], s56 offen offset:3072 sc1
    s_waitcnt vmcnt(15)
    v_mfma_f32_32x32x16_bf16 v[32:47], v[152:155], v[108:111], v[32:47]
    v_mfma_f32_32x32x16_bf16 v[64:79], v[156:159], v[108:111], v[64:79]
    buffer_load_dwordx4 v[108:111], v15, s[28:31], s56 offen offset:3072 sc1
    s_waitcnt vmcnt(15)
    v_mfma_f32_32x32x16_bf16 v[16:31], a[0:3], v[112:115], v[16:31]
    v_mfma_f32_32x32x16_bf16 v[48:63], a[4:7], v[112:115], v[48:63]
    s_mov_b32 s56, 8192
    buffer_load_dwordx4 v[112:115], v14, s[28:31], s56 offen offset:0 sc1
    s_waitcnt vmcnt(15)
    v_mfma_f32_32x32x16_bf16 v[32:47], a[0:3], v[116:119], v[32:47]
    v_mfma_f32_32x32x16_bf16 v[64:79], a[4:7], v[116:119], v[64:79]
    buffer_load_dwordx4 v[116:119], v15, s[28:31], s56 offen offset:0 sc1
    s_waitcnt vmcnt(15)
    v_mfma_f32_32x32x16_bf16 v[16:31], a[8:11], v[120:123], v[16:31]
    v_mfma_f32_32x32x16_bf16 v[48:63], a[12:15], v[120:123], v[48:63]
    buffer_load_dwordx4 v[120:123], v14, s[28:31], s56 offen offset:1024 sc1
    s_waitcnt vmcnt(15)
    v_mfma_f32_32x32x16_bf16 v[32:47], a[8:11], v[124:127], v[32:47]
    v_mfma_f32_32x32x16_bf16 v[64:79], a[12:15], v[124:127], v[64:79]
    buffer_load_dwordx4 v[124:127], v15, s[28:31], s56 offen offset:1024 sc1
    s_waitcnt vmcnt(15)
    v_mfma_f32_32x32x16_bf16 v[16:31], a[16:19], v[128:131], v[16:31]
    v_mfma_f32_32x32x16_bf16 v[48:63], a[20:23], v[128:131], v[48:63]
    buffer_load_dwordx4 v[128:131], v14, s[28:31], s56 offen offset:2048 sc1
    s_waitcnt vmcnt(15)
    v_mfma_f32_32x32x16_bf16 v[32:47], a[16:19], v[132:135], v[32:47]
    v_mfma_f32_32x32x16_bf16 v[64:79], a[20:23], v[132:135], v[64:79]
    buffer_load_dwordx4 v[132:135], v15, s[28:31], s56 offen offset:2048 sc1
    s_waitcnt vmcnt(15)
    v_mfma_f32_32x32x16_bf16 v[16:31], a[24:27], v[136:139], v[16:31]
    v_mfma_f32_32x32x16_bf16 v[48:63], a[28:31], v[136:139], v[48:63]
    buffer_load_dwordx4 v[136:139], v14, s[28:31], s56 offen offset:3072 sc1
    s_waitcnt vmcnt(15)
    v_mfma_f32_32x32x16_bf16 v[32:47], a[24:27], v[140:143], v[32:47]
    v_mfma_f32_32x32x16_bf16 v[64:79], a[28:31], v[140:143], v[64:79]
    buffer_load_dwordx4 v[140:143], v15, s[28:31], s56 offen offset:3072 sc1
    s_waitcnt vmcnt(15)
    v_mfma_f32_32x32x16_bf16 v[16:31], a[32:35], v[80:83], v[16:31]
    v_mfma_f32_32x32x16_bf16 v[48:63], a[36:39], v[80:83], v[48:63]
    s_mov_b32 s56, 12288
    buffer_load_dwordx4 v[80:83], v14, s[28:31], s56 offen offset:0 sc1
    s_waitcnt vmcnt(15)
    v_mfma_f32_32x32x16_bf16 v[32:47], a[32:35], v[84:87], v[32:47]
    v_mfma_f32_32x32x16_bf16 v[64:79], a[36:39], v[84:87], v[64:79]
    buffer_load_dwordx4 v[84:87], v15, s[28:31], s56 offen offset:0 sc1
    s_waitcnt vmcnt(15)
    v_mfma_f32_32x32x16_bf16 v[16:31], a[40:43], v[88:91], v[16:31]
    v_mfma_f32_32x32x16_bf16 v[48:63], a[44:47], v[88:91], v[48:63]
    buffer_load_dwordx4 v[88:91], v14, s[28:31], s56 offen offset:1024 sc1
    s_waitcnt vmcnt(15)
    v_mfma_f32_32x32x16_bf16 v[32:47], a[40:43], v[92:95], v[32:47]
    v_mfma_f32_32x32x16_bf16 v[64:79], a[44:47], v[92:95], v[64:79]
    buffer_load_dwordx4 v[92:95], v15, s[28:31], s56 offen offset:1024 sc1
    s_waitcnt vmcnt(15)
    v_mfma_f32_32x32x16_bf16 v[16:31], a[48:51], v[96:99], v[16:31]
    v_mfma_f32_32x32x16_bf16 v[48:63], a[52:55], v[96:99], v[48:63]
    buffer_load_dwordx4 v[96:99], v14, s[28:31], s56 offen offset:2048 sc1
    s_waitcnt vmcnt(15)
    v_mfma_f32_32x32x16_bf16 v[32:47], a[48:51], v[100:103], v[32:47]
    v_mfma_f32_32x32x16_bf16 v[64:79], a[52:55], v[100:103], v[64:79]
    buffer_load_dwordx4 v[100:103], v15, s[28:31], s56 offen offset:2048 sc1
    s_waitcnt vmcnt(15)
    v_mfma_f32_32x32x16_bf16 v[16:31], a[56:59], v[104:107], v[16:31]
    v_mfma_f32_32x32x16_bf16 v[48:63], a[60:63], v[104:107], v[48:63]
    buffer_load_dwordx4 v[104:107], v14, s[28:31], s56 offen offset:3072 sc1
    s_waitcnt vmcnt(15)
    v_mfma_f32_32x32x16_bf16 v[32:47], a[56:59], v[108:111], v[32:47]
    v_mfma_f32_32x32x16_bf16 v[64:79], a[60:63], v[108:111], v[64:79]
    buffer_load_dwordx4 v[108:111], v15, s[28:31], s56 offen offset:3072 sc1
    s_waitcnt vmcnt(15)
    v_mfma_f32_32x32x16_bf16 v[16:31], a[64:67], v[112:115], v[16:31]
    v_mfma_f32_32x32x16_bf16 v[48:63], a[68:71], v[112:115], v[48:63]
    s_mov_b32 s56, 16384
    buffer_load_dwordx4 v[112:115], v14, s[28:31], s56 offen offset:0 sc1
    s_waitcnt vmcnt(15)
    v_mfma_f32_32x32x16_bf16 v[32:47], a[64:67], v[116:119], v[32:47]
    v_mfma_f32_32x32x16_bf16 v[64:79], a[68:71], v[116:119], v[64:79]
    buffer_load_dwordx4 v[116:119], v15, s[28:31], s56 offen offset:0 sc1
    s_waitcnt vmcnt(15)
    v_mfma_f32_32x32x16_bf16 v[16:31], a[72:75], v[120:123], v[16:31]
    v_mfma_f32_32x32x16_bf16 v[48:63], a[76:79], v[120:123], v[48:63]
    buffer_load_dwordx4 v[120:123], v14, s[28:31], s56 offen offset:1024 sc1
    s_waitcnt vmcnt(15)
    v_mfma_f32_32x32x16_bf16 v[32:47], a[72:75], v[124:127], v[32:47]
    v_mfma_f32_32x32x16_bf16 v[64:79], a[76:79], v[124:127], v[64:79]
    buffer_load_dwordx4 v[124:127], v15, s[28:31], s56 offen offset:1024 sc1
    s_waitcnt vmcnt(15)
    v_mfma_f32_32x32x16_bf16 v[16:31], a[80:83], v[128:131], v[16:31]
    v_mfma_f32_32x32x16_bf16 v[48:63], a[84:87], v[128:131], v[48:63]
    buffer_load_dwordx4 v[128:131], v14, s[28:31], s56 offen offset:2048 sc1
    s_waitcnt vmcnt(15)
    v_mfma_f32_32x32x16_bf16 v[32:47], a[80:83], v[132:135], v[32:47]
    v_mfma_f32_32x32x16_bf16 v[64:79], a[84:87], v[132:135], v[64:79]
    buffer_load_dwordx4 v[132:135], v15, s[28:31], s56 offen offset:2048 sc1
    s_waitcnt vmcnt(15)
    v_mfma_f32_32x32x16_bf16 v[16:31], a[88:91], v[136:139], v[16:31]
    v_mfma_f32_32x32x16_bf16 v[48:63], a[92:95], v[136:139], v[48:63]
    buffer_load_dwordx4 v[136:139], v14, s[28:31], s56 offen offset:3072 sc1
    s_waitcnt vmcnt(15)
    v_mfma_f32_32x32x16_bf16 v[32:47], a[88:91], v[140:143], v[32:47]
    v_mfma_f32_32x32x16_bf16 v[64:79], a[92:95], v[140:143], v[64:79]
    buffer_load_dwordx4 v[140:143], v15, s[28:31], s56 offen offset:3072 sc1
    s_waitcnt vmcnt(15)
    v_mfma_f32_32x32x16_bf16 v[16:31], a[96:99], v[80:83], v[16:31]
    v_mfma_f32_32x32x16_bf16 v[48:63], a[100:103], v[80:83], v[48:63]
    s_mov_b32 s56, 20480
    buffer_load_dwordx4 v[80:83], v14, s[28:31], s56 offen offset:0 sc1
    s_waitcnt vmcnt(15)
    v_mfma_f32_32x32x16_bf16 v[32:47], a[96:99], v[84:87], v[32:47]
    v_mfma_f32_32x32x16_bf16 v[64:79], a[100:103], v[84:87], v[64:79]
    buffer_load_dwordx4 v[84:87], v15, s[28:31], s56 offen offset:0 sc1
    s_waitcnt vmcnt(15)
    v_mfma_f32_32x32x16_bf16 v[16:31], a[104:107], v[88:91], v[16:31]
    v_mfma_f32_32x32x16_bf16 v[48:63], a[108:111], v[88:91], v[48:63]
    buffer_load_dwordx4 v[88:91], v14, s[28:31], s56 offen offset:1024 sc1
    s_waitcnt vmcnt(15)
    v_mfma_f32_32x32x16_bf16 v[32:47], a[104:107], v[92:95], v[32:47]
    v_mfma_f32_32x32x16_bf16 v[64:79], a[108:111], v[92:95], v[64:79]
    buffer_load_dwordx4 v[92:95], v15, s[28:31], s56 offen offset:1024 sc1
    s_waitcnt vmcnt(15)
    v_mfma_f32_32x32x16_bf16 v[16:31], a[112:115], v[96:99], v[16:31]
    v_mfma_f32_32x32x16_bf16 v[48:63], a[116:119], v[96:99], v[48:63]
    buffer_load_dwordx4 v[96:99], v14, s[28:31], s56 offen offset:2048 sc1
    s_waitcnt vmcnt(15)
    v_mfma_f32_32x32x16_bf16 v[32:47], a[112:115], v[100:103], v[32:47]
    v_mfma_f32_32x32x16_bf16 v[64:79], a[116:119], v[100:103], v[64:79]
    buffer_load_dwordx4 v[100:103], v15, s[28:31], s56 offen offset:2048 sc1
    s_waitcnt vmcnt(15)
    v_mfma_f32_32x32x16_bf16 v[16:31], a[120:123], v[104:107], v[16:31]
    v_mfma_f32_32x32x16_bf16 v[48:63], a[124:127], v[104:107], v[48:63]
    buffer_load_dwordx4 v[104:107], v14, s[28:31], s56 offen offset:3072 sc1
    s_waitcnt vmcnt(15)
    v_mfma_f32_32x32x16_bf16 v[32:47], a[120:123], v[108:111], v[32:47]
    v_mfma_f32_32x32x16_bf16 v[64:79], a[124:127], v[108:111], v[64:79]
    buffer_load_dwordx4 v[108:111], v15, s[28:31], s56 offen offset:3072 sc1
    s_waitcnt vmcnt(15)
    v_mfma_f32_32x32x16_bf16 v[16:31], a[128:131], v[112:115], v[16:31]
    v_mfma_f32_32x32x16_bf16 v[48:63], a[132:135], v[112:115], v[48:63]
    s_mov_b32 s56, 24576
    buffer_load_dwordx4 v[112:115], v14, s[28:31], s56 offen offset:0 sc1
    s_waitcnt vmcnt(15)
    v_mfma_f32_32x32x16_bf16 v[32:47], a[128:131], v[116:119], v[32:47]
    v_mfma_f32_32x32x16_bf16 v[64:79], a[132:135], v[116:119], v[64:79]
    buffer_load_dwordx4 v[116:119], v15, s[28:31], s56 offen offset:0 sc1
    s_waitcnt vmcnt(15)
    v_mfma_f32_32x32x16_bf16 v[16:31], a[136:139], v[120:123], v[16:31]
    v_mfma_f32_32x32x16_bf16 v[48:63], a[140:143], v[120:123], v[48:63]
    buffer_load_dwordx4 v[120:123], v14, s[28:31], s56 offen offset:1024 sc1
    s_waitcnt vmcnt(15)
    v_mfma_f32_32x32x16_bf16 v[32:47], a[136:139], v[124:127], v[32:47]
    v_mfma_f32_32x32x16_bf16 v[64:79], a[140:143], v[124:127], v[64:79]
    buffer_load_dwordx4 v[124:127], v15, s[28:31], s56 offen offset:1024 sc1
    s_waitcnt vmcnt(15)
    v_mfma_f32_32x32x16_bf16 v[16:31], a[144:147], v[128:131], v[16:31]
    v_mfma_f32_32x32x16_bf16 v[48:63], a[148:151], v[128:131], v[48:63]
    buffer_load_dwordx4 v[128:131], v14, s[28:31], s56 offen offset:2048 sc1
    s_waitcnt vmcnt(15)
    v_mfma_f32_32x32x16_bf16 v[32:47], a[144:147], v[132:135], v[32:47]
    v_mfma_f32_32x32x16_bf16 v[64:79], a[148:151], v[132:135], v[64:79]
    buffer_load_dwordx4 v[132:135], v15, s[28:31], s56 offen offset:2048 sc1
    s_waitcnt vmcnt(15)
    v_mfma_f32_32x32x16_bf16 v[16:31], a[152:155], v[136:139], v[16:31]
    v_mfma_f32_32x32x16_bf16 v[48:63], a[156:159], v[136:139], v[48:63]
    buffer_load_dwordx4 v[136:139], v14, s[28:31], s56 offen offset:3072 sc1
    s_waitcnt vmcnt(15)
    v_mfma_f32_32x32x16_bf16 v[32:47], a[152:155], v[140:143], v[32:47]
    v_mfma_f32_32x32x16_bf16 v[64:79], a[156:159], v[140:143], v[64:79]
    buffer_load_dwordx4 v[140:143], v15, s[28:31], s56 offen offset:3072 sc1
    s_waitcnt vmcnt(15)
    v_mfma_f32_32x32x16_bf16 v[16:31], a[160:163], v[80:83], v[16:31]
    v_mfma_f32_32x32x16_bf16 v[48:63], a[164:167], v[80:83], v[48:63]
    s_mov_b32 s56, 28672
    buffer_load_dwordx4 v[80:83], v14, s[28:31], s56 offen offset:0 sc1
    s_waitcnt vmcnt(15)
    v_mfma_f32_32x32x16_bf16 v[32:47], a[160:163], v[84:87], v[32:47]
    v_mfma_f32_32x32x16_bf16 v[64:79], a[164:167], v[84:87], v[64:79]
    buffer_load_dwordx4 v[84:87], v15, s[28:31], s56 offen offset:0 sc1
    s_waitcnt vmcnt(15)
    v_mfma_f32_32x32x16_bf16 v[16:31], a[168:171], v[88:91], v[16:31]
    v_mfma_f32_32x32x16_bf16 v[48:63], a[172:175], v[88:91], v[48:63]
    buffer_load_dwordx4 v[88:91], v14, s[28:31], s56 offen offset:1024 sc1
    s_waitcnt vmcnt(15)
    v_mfma_f32_32x32x16_bf16 v[32:47], a[168:171], v[92:95], v[32:47]
    v_mfma_f32_32x32x16_bf16 v[64:79], a[172:175], v[92:95], v[64:79]
    buffer_load_dwordx4 v[92:95], v15, s[28:31], s56 offen offset:1024 sc1
    s_waitcnt vmcnt(15)
    v_mfma_f32_32x32x16_bf16 v[16:31], a[176:179], v[96:99], v[16:31]
    v_mfma_f32_32x32x16_bf16 v[48:63], a[180:183], v[96:99], v[48:63]
    buffer_load_dwordx4 v[96:99], v14, s[28:31], s56 offen offset:2048 sc1
    s_waitcnt vmcnt(15)
    v_mfma_f32_32x32x16_bf16 v[32:47], a[176:179], v[100:103], v[32:47]
    v_mfma_f32_32x32x16_bf16 v[64:79], a[180:183], v[100:103], v[64:79]
    buffer_load_dwordx4 v[100:103], v15, s[28:31], s56 offen offset:2048 sc1
    s_waitcnt vmcnt(15)
    v_mfma_f32_32x32x16_bf16 v[16:31], a[184:187], v[104:107], v[16:31]
    v_mfma_f32_32x32x16_bf16 v[48:63], a[188:191], v[104:107], v[48:63]
    buffer_load_dwordx4 v[104:107], v14, s[28:31], s56 offen offset:3072 sc1
    s_waitcnt vmcnt(15)
    v_mfma_f32_32x32x16_bf16 v[32:47], a[184:187], v[108:111], v[32:47]
    v_mfma_f32_32x32x16_bf16 v[64:79], a[188:191], v[108:111], v[64:79]
    buffer_load_dwordx4 v[108:111], v15, s[28:31], s56 offen offset:3072 sc1
    s_waitcnt vmcnt(15)
    v_mfma_f32_32x32x16_bf16 v[16:31], a[192:195], v[112:115], v[16:31]
    v_mfma_f32_32x32x16_bf16 v[48:63], a[196:199], v[112:115], v[48:63]
    s_mov_b32 s56, 32768
    buffer_load_dwordx4 v[112:115], v14, s[28:31], s56 offen offset:0 sc1
    s_waitcnt vmcnt(15)
    v_mfma_f32_32x32x16_bf16 v[32:47], a[192:195], v[116:119], v[32:47]
    v_mfma_f32_32x32x16_bf16 v[64:79], a[196:199], v[116:119], v[64:79]
    buffer_load_dwordx4 v[116:119], v15, s[28:31], s56 offen offset:0 sc1
    s_waitcnt vmcnt(15)
    v_mfma_f32_32x32x16_bf16 v[16:31], a[200:203], v[120:123], v[16:31]
    v_mfma_f32_32x32x16_bf16 v[48:63], a[204:207], v[120:123], v[48:63]
    buffer_load_dwordx4 v[120:123], v14, s[28:31], s56 offen offset:1024 sc1
    s_waitcnt vmcnt(15)
    v_mfma_f32_32x32x16_bf16 v[32:47], a[200:203], v[124:127], v[32:47]
    v_mfma_f32_32x32x16_bf16 v[64:79], a[204:207], v[124:127], v[64:79]
    buffer_load_dwordx4 v[124:127], v15, s[28:31], s56 offen offset:1024 sc1
    s_waitcnt vmcnt(15)
    v_mfma_f32_32x32x16_bf16 v[16:31], a[208:211], v[128:131], v[16:31]
    v_mfma_f32_32x32x16_bf16 v[48:63], a[212:215], v[128:131], v[48:63]
    buffer_load_dwordx4 v[128:131], v14, s[28:31], s56 offen offset:2048 sc1
    s_waitcnt vmcnt(15)
    v_mfma_f32_32x32x16_bf16 v[32:47], a[208:211], v[132:135], v[32:47]
    v_mfma_f32_32x32x16_bf16 v[64:79], a[212:215], v[132:135], v[64:79]
    buffer_load_dwordx4 v[132:135], v15, s[28:31], s56 offen offset:2048 sc1
    s_waitcnt vmcnt(15)
    v_mfma_f32_32x32x16_bf16 v[16:31], a[216:219], v[136:139], v[16:31]
    v_mfma_f32_32x32x16_bf16 v[48:63], a[220:223], v[136:139], v[48:63]
    buffer_load_dwordx4 v[136:139], v14, s[28:31], s56 offen offset:3072 sc1
    s_waitcnt vmcnt(15)
    v_mfma_f32_32x32x16_bf16 v[32:47], a[216:219], v[140:143], v[32:47]
    v_mfma_f32_32x32x16_bf16 v[64:79], a[220:223], v[140:143], v[64:79]
    buffer_load_dwordx4 v[140:143], v15, s[28:31], s56 offen offset:3072 sc1
    s_waitcnt vmcnt(15)
    v_mfma_f32_32x32x16_bf16 v[16:31], a[224:227], v[80:83], v[16:31]
    v_mfma_f32_32x32x16_bf16 v[48:63], a[228:231], v[80:83], v[48:63]
    s_mov_b32 s56, 36864
    buffer_load_dwordx4 v[80:83], v14, s[28:31], s56 offen offset:0 sc1
    s_waitcnt vmcnt(15)
    v_mfma_f32_32x32x16_bf16 v[32:47], a[224:227], v[84:87], v[32:47]
    v_mfma_f32_32x32x16_bf16 v[64:79], a[228:231], v[84:87], v[64:79]
    buffer_load_dwordx4 v[84:87], v15, s[28:31], s56 offen offset:0 sc1
    s_waitcnt vmcnt(15)
    v_mfma_f32_32x32x16_bf16 v[16:31], a[232:235], v[88:91], v[16:31]
    v_mfma_f32_32x32x16_bf16 v[48:63], a[236:239], v[88:91], v[48:63]
    buffer_load_dwordx4 v[88:91], v14, s[28:31], s56 offen offset:1024 sc1
    s_waitcnt vmcnt(15)
    v_mfma_f32_32x32x16_bf16 v[32:47], a[232:235], v[92:95], v[32:47]
    v_mfma_f32_32x32x16_bf16 v[64:79], a[236:239], v[92:95], v[64:79]
    buffer_load_dwordx4 v[92:95], v15, s[28:31], s56 offen offset:1024 sc1
    s_waitcnt vmcnt(15)
    v_mfma_f32_32x32x16_bf16 v[16:31], a[240:243], v[96:99], v[16:31]
    v_mfma_f32_32x32x16_bf16 v[48:63], a[244:247], v[96:99], v[48:63]
    buffer_load_dwordx4 v[96:99], v14, s[28:31], s56 offen offset:2048 sc1
    s_waitcnt vmcnt(15)
    v_mfma_f32_32x32x16_bf16 v[32:47], a[240:243], v[100:103], v[32:47]
    v_mfma_f32_32x32x16_bf16 v[64:79], a[244:247], v[100:103], v[64:79]
    buffer_load_dwordx4 v[100:103], v15, s[28:31], s56 offen offset:2048 sc1
    s_waitcnt vmcnt(15)
    v_mfma_f32_32x32x16_bf16 v[16:31], a[248:251], v[104:107], v[16:31]
    v_mfma_f32_32x32x16_bf16 v[48:63], a[252:255], v[104:107], v[48:63]
    buffer_load_dwordx4 v[104:107], v14, s[28:31], s56 offen offset:3072 sc1
    s_waitcnt vmcnt(15)
    v_mfma_f32_32x32x16_bf16 v[32:47], a[248:251], v[108:111], v[32:47]
    v_mfma_f32_32x32x16_bf16 v[64:79], a[252:255], v[108:111], v[64:79]
    buffer_load_dwordx4 v[108:111], v15, s[28:31], s56 offen offset:3072 sc1
    s_waitcnt vmcnt(15)
    v_mfma_f32_32x32x16_bf16 v[16:31], v[160:163], v[112:115], v[16:31]
    v_mfma_f32_32x32x16_bf16 v[48:63], v[164:167], v[112:115], v[48:63]
    s_mov_b32 s56, 40960
    buffer_load_dwordx4 v[112:115], v14, s[28:31], s56 offen offset:0 sc1
    s_waitcnt vmcnt(15)
    v_mfma_f32_32x32x16_bf16 v[32:47], v[160:163], v[116:119], v[32:47]
    v_mfma_f32_32x32x16_bf16 v[64:79], v[164:167], v[116:119], v[64:79]
    buffer_load_dwordx4 v[116:119], v15, s[28:31], s56 offen offset:0 sc1
    s_waitcnt vmcnt(15)
    v_mfma_f32_32x32x16_bf16 v[16:31], v[168:171], v[120:123], v[16:31]
    v_mfma_f32_32x32x16_bf16 v[48:63], v[172:175], v[120:123], v[48:63]
    buffer_load_dwordx4 v[120:123], v14, s[28:31], s56 offen offset:1024 sc1
    s_waitcnt vmcnt(15)
    v_mfma_f32_32x32x16_bf16 v[32:47], v[168:171], v[124:127], v[32:47]
    v_mfma_f32_32x32x16_bf16 v[64:79], v[172:175], v[124:127], v[64:79]
    buffer_load_dwordx4 v[124:127], v15, s[28:31], s56 offen offset:1024 sc1
    s_waitcnt vmcnt(15)
    v_mfma_f32_32x32x16_bf16 v[16:31], v[176:179], v[128:131], v[16:31]
    v_mfma_f32_32x32x16_bf16 v[48:63], v[180:183], v[128:131], v[48:63]
    s_mov_b32 s56, 61440
    buffer_load_dwordx4 v[128:131], v14, s[28:31], s56 offen offset:2048 sc1
    s_waitcnt vmcnt(15)
    v_mfma_f32_32x32x16_bf16 v[32:47], v[176:179], v[132:135], v[32:47]
    v_mfma_f32_32x32x16_bf16 v[64:79], v[180:183], v[132:135], v[64:79]
    buffer_load_dwordx4 v[132:135], v15, s[28:31], s56 offen offset:2048 sc1
    s_waitcnt vmcnt(15)
    v_mfma_f32_32x32x16_bf16 v[16:31], v[184:187], v[136:139], v[16:31]
    v_mfma_f32_32x32x16_bf16 v[48:63], v[188:191], v[136:139], v[48:63]
    buffer_load_dwordx4 v[136:139], v14, s[28:31], s56 offen offset:3072 sc1
    s_waitcnt vmcnt(15)
    v_mfma_f32_32x32x16_bf16 v[32:47], v[184:187], v[140:143], v[32:47]
    v_mfma_f32_32x32x16_bf16 v[64:79], v[188:191], v[140:143], v[64:79]
    buffer_load_dwordx4 v[140:143], v15, s[28:31], s56 offen offset:3072 sc1
    s_waitcnt vmcnt(15)
    v_mfma_f32_32x32x16_bf16 v[16:31], v[192:195], v[80:83], v[16:31]
    v_mfma_f32_32x32x16_bf16 v[48:63], v[196:199], v[80:83], v[48:63]
    s_waitcnt vmcnt(14)
    v_mfma_f32_32x32x16_bf16 v[32:47], v[192:195], v[84:87], v[32:47]
    v_mfma_f32_32x32x16_bf16 v[64:79], v[196:199], v[84:87], v[64:79]
    s_waitcnt vmcnt(13)
    v_mfma_f32_32x32x16_bf16 v[16:31], v[200:203], v[88:91], v[16:31]
    v_mfma_f32_32x32x16_bf16 v[48:63], v[204:207], v[88:91], v[48:63]
    s_waitcnt vmcnt(12)
    v_mfma_f32_32x32x16_bf16 v[32:47], v[200:203], v[92:95], v[32:47]
    v_mfma_f32_32x32x16_bf16 v[64:79], v[204:207], v[92:95], v[64:79]
    s_waitcnt vmcnt(11)
    v_mfma_f32_32x32x16_bf16 v[16:31], v[208:211], v[96:99], v[16:31]
    v_mfma_f32_32x32x16_bf16 v[48:63], v[212:215], v[96:99], v[48:63]
    s_waitcnt vmcnt(10)
    v_mfma_f32_32x32x16_bf16 v[32:47], v[208:211], v[100:103], v[32:47]
    v_mfma_f32_32x32x16_bf16 v[64:79], v[212:215], v[100:103], v[64:79]
    s_waitcnt vmcnt(9)
    v_mfma_f32_32x32x16_bf16 v[16:31], v[216:219], v[104:107], v[16:31]
    v_mfma_f32_32x32x16_bf16 v[48:63], v[220:223], v[104:107], v[48:63]
    s_waitcnt vmcnt(8)
    v_mfma_f32_32x32x16_bf16 v[32:47], v[216:219], v[108:111], v[32:47]
    v_mfma_f32_32x32x16_bf16 v[64:79], v[220:223], v[108:111], v[64:79]
    s_waitcnt vmcnt(7)
    v_mfma_f32_32x32x16_bf16 v[16:31], v[224:227], v[112:115], v[16:31]
    v_mfma_f32_32x32x16_bf16 v[48:63], v[228:231], v[112:115], v[48:63]
    s_waitcnt vmcnt(6)
    v_mfma_f32_32x32x16_bf16 v[32:47], v[224:227], v[116:119], v[32:47]
    v_mfma_f32_32x32x16_bf16 v[64:79], v[228:231], v[116:119], v[64:79]
    s_waitcnt vmcnt(5)
    v_mfma_f32_32x32x16_bf16 v[16:31], v[232:235], v[120:123], v[16:31]
    s_waitcnt vmcnt(63)
    ds_read_b64_tr_b16 v[144:145], v4 offset:4096
    ds_read_b64_tr_b16 v[146:147], v4 offset:5120
    ds_read_b64_tr_b16 v[148:149], v5 offset:4096
    ds_read_b64_tr_b16 v[150:151], v5 offset:5120
    v_mfma_f32_32x32x16_bf16 v[48:63], v[236:239], v[120:123], v[48:63]
    s_waitcnt vmcnt(4)
    v_mfma_f32_32x32x16_bf16 v[32:47], v[232:235], v[124:127], v[32:47]
    v_mfma_f32_32x32x16_bf16 v[64:79], v[236:239], v[124:127], v[64:79]
    s_waitcnt vmcnt(3) lgkmcnt(2)
    v_mfma_f32_32x32x16_bf16 v[16:31], v[144:147], v[128:131], v[16:31]
    ds_read_b64_tr_b16 v[152:153], v4 offset:6144
    ds_read_b64_tr_b16 v[154:155], v4 offset:7168
    ds_read_b64_tr_b16 v[156:157], v5 offset:6144
    ds_read_b64_tr_b16 v[158:159], v5 offset:7168
    s_waitcnt lgkmcnt(4)
    v_mfma_f32_32x32x16_bf16 v[48:63], v[148:151], v[128:131], v[48:63]
    s_waitcnt vmcnt(2)
    v_mfma_f32_32x32x16_bf16 v[32:47], v[144:147], v[132:135], v[32:47]
    v_mfma_f32_32x32x16_bf16 v[64:79], v[148:151], v[132:135], v[64:79]
    s_waitcnt vmcnt(0) lgkmcnt(2)
    v_mfma_f32_32x32x16_bf16 v[32:47], v[152:155], v[140:143], v[32:47]
    s_waitcnt lgkmcnt(0)
    v_mfma_f32_32x32x16_bf16 v[48:63], v[156:159], v[136:139], v[48:63]
    v_mfma_f32_32x32x16_bf16 v[64:79], v[156:159], v[140:143], v[64:79]
    v_mfma_f32_32x32x16_bf16 v[16:31], v[152:155], v[136:139], v[16:31]
    v_lshlrev_b32 v2, 4, v1
    v_add_u32 v3, s58, v2
    s_xor_b32 s3, s40, 1
    s_mul_i32 s3, s3, 40960
    v_add_u32 v10, s3, v2
    s_xor_b32 s3, s40, 2
    s_mul_i32 s3, s3, 40960
    v_add_u32 v11, s3, v2
    s_xor_b32 s3, s40, 3
    s_mul_i32 s3, s3, 40960
    v_add_u32 v12, s3, v2
    ds_write_b128 v3, v[32:35] offset:4096
    ds_write_b128 v3, v[36:39] offset:5120
    ds_write_b128 v3, v[40:43] offset:6144
    ds_write_b128 v3, v[44:47] offset:7168
    ds_write_b128 v3, v[48:51] offset:8192
    ds_write_b128 v3, v[52:55] offset:9216
    ds_write_b128 v3, v[56:59] offset:10240
    ds_write_b128 v3, v[60:63] offset:11264
    ds_write_b128 v3, v[64:67] offset:12288
    ds_write_b128 v3, v[68:71] offset:13312
    ds_write_b128 v3, v[72:75] offset:14336
    ds_write_b128 v3, v[76:79] offset:15360
    s_waitcnt lgkmcnt(0)
    s_barrier
    ds_read_b128 v[96:99], v10 offset:4096
    ds_read_b128 v[100:103], v10 offset:5120
    ds_read_b128 v[104:107], v10 offset:6144
    ds_read_b128 v[108:111], v10 offset:7168
    ds_read_b128 v[112:115], v11 offset:8192
    ds_read_b128 v[116:119], v11 offset:9216
    ds_read_b128 v[120:123], v11 offset:10240
    ds_read_b128 v[124:127], v11 offset:11264
    ds_read_b128 v[128:131], v12 offset:12288
    ds_read_b128 v[132:135], v12 offset:13312
    ds_read_b128 v[136:139], v12 offset:14336
    ds_read_b128 v[140:143], v12 offset:15360
    s_mov_b32 s32, s84
    s_mov_b32 s33, s85
    s_mov_b32 s34, 1769472
    s_mov_b32 s35, 0x20000
    s_lshl_b32 s3, s90, 6
    s_lshl_b32 s56, s41, 5
    s_add_u32 s3, s3, s56
    v_and_b32 v5, 31, v1
    v_add_u32 v5, s3, v5
    v_mul_u32_u24 v5, 2304, v5
    v_lshrrev_b32 v6, 5, v1
    v_lshl_add_u32 v5, v6, 4, v5
    s_mul_i32 s3, s43, 1152
    s_lshl_b32 s56, s91, 7
    s_add_u32 s3, s3, s56
    s_lshl_b32 s56, s42, 6
    s_add_u32 s3, s3, s56
    s_waitcnt lgkmcnt(11)
    v_pk_add_f32 v[16:17], v[16:17], v[96:97]
    v_pk_add_f32 v[18:19], v[18:19], v[98:99]
    s_waitcnt lgkmcnt(10)
    v_pk_add_f32 v[20:21], v[20:21], v[100:101]
    v_pk_add_f32 v[22:23], v[22:23], v[102:103]
    s_waitcnt lgkmcnt(9)
    v_pk_add_f32 v[24:25], v[24:25], v[104:105]
    v_pk_add_f32 v[26:27], v[26:27], v[106:107]
    s_waitcnt lgkmcnt(8)
    v_pk_add_f32 v[28:29], v[28:29], v[108:109]
    v_pk_add_f32 v[30:31], v[30:31], v[110:111]
    s_waitcnt lgkmcnt(7)
    v_pk_add_f32 v[16:17], v[16:17], v[112:113]
    v_pk_add_f32 v[18:19], v[18:19], v[114:115]
    s_waitcnt lgkmcnt(6)
    v_pk_add_f32 v[20:21], v[20:21], v[116:117]
    v_pk_add_f32 v[22:23], v[22:23], v[118:119]
    s_waitcnt lgkmcnt(5)
    v_pk_add_f32 v[24:25], v[24:25], v[120:121]
    v_pk_add_f32 v[26:27], v[26:27], v[122:123]
    s_waitcnt lgkmcnt(4)
    v_pk_add_f32 v[28:29], v[28:29], v[124:125]
    v_pk_add_f32 v[30:31], v[30:31], v[126:127]
    s_waitcnt lgkmcnt(3)
    v_pk_add_f32 v[16:17], v[16:17], v[128:129]
    v_pk_add_f32 v[18:19], v[18:19], v[130:131]
    s_waitcnt lgkmcnt(2)
    v_pk_add_f32 v[20:21], v[20:21], v[132:133]
    v_pk_add_f32 v[22:23], v[22:23], v[134:135]
    s_waitcnt lgkmcnt(1)
    v_pk_add_f32 v[24:25], v[24:25], v[136:137]
    v_pk_add_f32 v[26:27], v[26:27], v[138:139]
    s_waitcnt lgkmcnt(0)
    v_pk_add_f32 v[28:29], v[28:29], v[140:141]
    v_pk_add_f32 v[30:31], v[30:31], v[142:143]
    v_cvt_pk_bf16_f32 v32, v16, v17
    v_cvt_pk_bf16_f32 v33, v18, v19
    v_cvt_pk_bf16_f32 v34, v20, v21
    v_cvt_pk_bf16_f32 v35, v22, v23
    v_cvt_pk_bf16_f32 v36, v24, v25
    v_cvt_pk_bf16_f32 v37, v26, v27
    v_cvt_pk_bf16_f32 v38, v28, v29
    v_cvt_pk_bf16_f32 v39, v30, v31
    buffer_store_dwordx4 v[32:35], v5, s[32:35], s3 offen
    buffer_store_dwordx4 v[36:39], v5, s[32:35], s3 offen offset:32
L_end:
    s_endpgm
L_notile:
    s_waitcnt vmcnt(0)
    s_barrier
    s_cmp_lg_u32 s40, 0
    s_cbranch_scc1 L_help
    s_lshl_b32 s3, s43, 3
    s_add_u32 s3, s3, s44
    s_lshl_b32 s3, s3, 2
    s_lshr_b32 s56, s45, 2
    s_add_u32 s3, s3, s56
    s_lshl_b32 s3, s3, 2
    v_mov_b32 v10, 1
    s_mov_b64 exec, 1
    buffer_atomic_add v10, off, s[36:39], s3 sc1
    s_mov_b64 exec, -1
L_help:
    s_endpgm
L_poll:
    s_sleep 8
    buffer_load_dword v10, off, s[36:39], s92 sc1
    buffer_load_dword v11, off, s[36:39], s93 sc1
    s_waitcnt vmcnt(0)
    v_min_u32 v10, v10, v11
    s_add_u32 s50, s50, 1
    v_readfirstlane_b32 s3, v10
    s_cmp_ge_u32 s3, 4
    s_cbranch_scc1 L_go
    s_cmp_lt_u32 s50, 0x40000
    s_cbranch_scc1 L_poll
    s_branch L_go
L_tr0:
    s_call_b64 s[54:55], L_slow2
    s_branch L_back0
L_tr1:
    s_call_b64 s[54:55], L_slow0
    s_branch L_back1
L_tr2:
    s_call_b64 s[54:55], L_slow1
    s_branch L_back2
L_tr3:
    s_call_b64 s[54:55], L_slow2
    s_branch L_back3
L_tr4:
    s_call_b64 s[54:55], L_slow0
    s_branch L_back4
L_tr5:
    s_call_b64 s[54:55], L_slow1
    s_branch L_back5
L_tr6:
    s_call_b64 s[54:55], L_slow2
    s_branch L_back6
L_tr7:
    s_call_b64 s[54:55], L_slow0
    s_branch L_back7
L_tr8:
    s_call_b64 s[54:55], L_slow1
    s_branch L_back8
L_tr9:
    s_call_b64 s[54:55], L_slow2
    s_branch L_back9
L_tr10:
    s_call_b64 s[54:55], L_slow0
    s_branch L_back10
L_tr11:
    s_call_b64 s[54:55], L_slow1
    s_branch L_back11
L_tr12:
    s_call_b64 s[54:55], L_slow2
    s_branch L_back12
L_tr13:
    s_call_b64 s[54:55], L_slow0
    s_branch L_back13
L_tr14:
    s_call_b64 s[54:55], L_slow1
    s_branch L_back14
L_tr15:
    s_call_b64 s[54:55], L_slow2
    s_branch L_back15
L_tr16:
    s_call_b64 s[54:55], L_slow0
    s_branch L_back16
L_tr17:
    s_call_b64 s[54:55], L_slow1
    s_branch L_back17
L_tr18:
    s_call_b64 s[54:55], L_slow2
    s_branch L_back18
L_tr19:
    s_call_b64 s[54:55], L_slow0
    s_branch L_back19
L_tr20:
    s_call_b64 s[54:55], L_slow1
    s_branch L_back20
L_tr21:
    s_call_b64 s[54:55], L_slow2
    s_branch L_back21
L_slow0:
    v_max3_f32 v8, v16, v17, v18
    v_max3_f32 v8, v8, v19, v20
    v_max3_f32 v8, v8, v21, v22
    v_max3_f32 v8, v8, v23, v24
    v_max3_f32 v8, v8, v25, v26
    v_max3_f32 v8, v8, v27, v28
    v_max3_f32 v8, v8, v29, v30
    v_max_f32 v8, v8, v31
    v_mov_b32 v9, v8
    s_nop 1
    v_permlane32_swap_b32 v8, v9
    v_max_f32 v8, v8, v9
    v_max_f32 v8, 0, v8
    v_sub_f32 v10, 0, v8
    v_exp_f32 v10, v10
    v_sub_f32 v64, v64, v8
    v_mov_b32 v65, v64
    v_mov_b32 v66, v64
    v_mov_b32 v67, v64
    v_mov_b32 v68, v64
    v_mov_b32 v69, v64
    v_mov_b32 v70, v64
    v_mov_b32 v71, v64
    v_mov_b32 v72, v64
    v_mov_b32 v73, v64
    v_mov_b32 v74, v64
    v_mov_b32 v75, v64
    v_mov_b32 v76, v64
    v_mov_b32 v77, v64
    v_mov_b32 v78, v64
    v_mov_b32 v79, v64
    v_mul_f32 v247, v247, v10
    v_accvgpr_read_b32 v11, a0
    v_accvgpr_read_b32 v12, a1
    v_mul_f32 v11, v11, v10
    v_mul_f32 v12, v12, v10
    v_accvgpr_write_b32 a0, v11
    v_accvgpr_write_b32 a1, v12
    v_accvgpr_read_b32 v11, a2
    v_accvgpr_read_b32 v12, a3
    v_mul_f32 v11, v11, v10
    v_mul_f32 v12, v12, v10
    v_accvgpr_write_b32 a2, v11
    v_accvgpr_write_b32 a3, v12
    v_accvgpr_read_b32 v11, a4
    v_accvgpr_read_b32 v12, a5
    v_mul_f32 v11, v11, v10
    v_mul_f32 v12, v12, v10
    v_accvgpr_write_b32 a4, v11
    v_accvgpr_write_b32 a5, v12
    v_accvgpr_read_b32 v11, a6
    v_accvgpr_read_b32 v12, a7
    v_mul_f32 v11, v11, v10
    v_mul_f32 v12, v12, v10
    v_accvgpr_write_b32 a6, v11
    v_accvgpr_write_b32 a7, v12
    v_accvgpr_read_b32 v11, a8
    v_accvgpr_read_b32 v12, a9
    v_mul_f32 v11, v11, v10
    v_mul_f32 v12, v12, v10
    v_accvgpr_write_b32 a8, v11
    v_accvgpr_write_b32 a9, v12
    v_accvgpr_read_b32 v11, a10
    v_accvgpr_read_b32 v12, a11
    v_mul_f32 v11, v11, v10
    v_mul_f32 v12, v12, v10
    v_accvgpr_write_b32 a10, v11
    v_accvgpr_write_b32 a11, v12
    v_accvgpr_read_b32 v11, a12
    v_accvgpr_read_b32 v12, a13
    v_mul_f32 v11, v11, v10
    v_mul_f32 v12, v12, v10
    v_accvgpr_write_b32 a12, v11
    v_accvgpr_write_b32 a13, v12
    v_accvgpr_read_b32 v11, a14
    v_accvgpr_read_b32 v12, a15
    v_mul_f32 v11, v11, v10
    v_mul_f32 v12, v12, v10
    v_accvgpr_write_b32 a14, v11
    v_accvgpr_write_b32 a15, v12
    v_accvgpr_read_b32 v11, a16
    v_accvgpr_read_b32 v12, a17
    v_mul_f32 v11, v11, v10
    v_mul_f32 v12, v12, v10
    v_accvgpr_write_b32 a16, v11
    v_accvgpr_write_b32 a17, v12
    v_accvgpr_read_b32 v11, a18
    v_accvgpr_read_b32 v12, a19
    v_mul_f32 v11, v11, v10
    v_mul_f32 v12, v12, v10
    v_accvgpr_write_b32 a18, v11
    v_accvgpr_write_b32 a19, v12
    v_accvgpr_read_b32 v11, a20
    v_accvgpr_read_b32 v12, a21
    v_mul_f32 v11, v11, v10
    v_mul_f32 v12, v12, v10
    v_accvgpr_write_b32 a20, v11
    v_accvgpr_write_b32 a21, v12
    v_accvgpr_read_b32 v11, a22
    v_accvgpr_read_b32 v12, a23
    v_mul_f32 v11, v11, v10
    v_mul_f32 v12, v12, v10
    v_accvgpr_write_b32 a22, v11
    v_accvgpr_write_b32 a23, v12
    v_accvgpr_read_b32 v11, a24
    v_accvgpr_read_b32 v12, a25
    v_mul_f32 v11, v11, v10
    v_mul_f32 v12, v12, v10
    v_accvgpr_write_b32 a24, v11
    v_accvgpr_write_b32 a25, v12
    v_accvgpr_read_b32 v11, a26
    v_accvgpr_read_b32 v12, a27
    v_mul_f32 v11, v11, v10
    v_mul_f32 v12, v12, v10
    v_accvgpr_write_b32 a26, v11
    v_accvgpr_write_b32 a27, v12
    v_accvgpr_read_b32 v11, a28
    v_accvgpr_read_b32 v12, a29
    v_mul_f32 v11, v11, v10
    v_mul_f32 v12, v12, v10
    v_accvgpr_write_b32 a28, v11
    v_accvgpr_write_b32 a29, v12
    v_accvgpr_read_b32 v11, a30
    v_accvgpr_read_b32 v12, a31
    v_mul_f32 v11, v11, v10
    v_mul_f32 v12, v12, v10
    v_accvgpr_write_b32 a30, v11
    v_accvgpr_write_b32 a31, v12
    v_accvgpr_read_b32 v11, a32
    v_accvgpr_read_b32 v12, a33
    v_mul_f32 v11, v11, v10
    v_mul_f32 v12, v12, v10
    v_accvgpr_write_b32 a32, v11
    v_accvgpr_write_b32 a33, v12
    v_accvgpr_read_b32 v11, a34
    v_accvgpr_read_b32 v12, a35
    v_mul_f32 v11, v11, v10
    v_mul_f32 v12, v12, v10
    v_accvgpr_write_b32 a34, v11
    v_accvgpr_write_b32 a35, v12
    v_accvgpr_read_b32 v11, a36
    v_accvgpr_read_b32 v12, a37
    v_mul_f32 v11, v11, v10
    v_mul_f32 v12, v12, v10
    v_accvgpr_write_b32 a36, v11
    v_accvgpr_write_b32 a37, v12
    v_accvgpr_read_b32 v11, a38
    v_accvgpr_read_b32 v12, a39
    v_mul_f32 v11, v11, v10
    v_mul_f32 v12, v12, v10
    v_accvgpr_write_b32 a38, v11
    v_accvgpr_write_b32 a39, v12
    v_accvgpr_read_b32 v11, a40
    v_accvgpr_read_b32 v12, a41
    v_mul_f32 v11, v11, v10
    v_mul_f32 v12, v12, v10
    v_accvgpr_write_b32 a40, v11
    v_accvgpr_write_b32 a41, v12
    v_accvgpr_read_b32 v11, a42
    v_accvgpr_read_b32 v12, a43
    v_mul_f32 v11, v11, v10
    v_mul_f32 v12, v12, v10
    v_accvgpr_write_b32 a42, v11
    v_accvgpr_write_b32 a43, v12
    v_accvgpr_read_b32 v11, a44
    v_accvgpr_read_b32 v12, a45
    v_mul_f32 v11, v11, v10
    v_mul_f32 v12, v12, v10
    v_accvgpr_write_b32 a44, v11
    v_accvgpr_write_b32 a45, v12
    v_accvgpr_read_b32 v11, a46
    v_accvgpr_read_b32 v12, a47
    v_mul_f32 v11, v11, v10
    v_mul_f32 v12, v12, v10
    v_accvgpr_write_b32 a46, v11
    v_accvgpr_write_b32 a47, v12
    v_accvgpr_read_b32 v11, a48
    v_accvgpr_read_b32 v12, a49
    v_mul_f32 v11, v11, v10
    v_mul_f32 v12, v12, v10
    v_accvgpr_write_b32 a48, v11
    v_accvgpr_write_b32 a49, v12
    v_accvgpr_read_b32 v11, a50
    v_accvgpr_read_b32 v12, a51
    v_mul_f32 v11, v11, v10
    v_mul_f32 v12, v12, v10
    v_accvgpr_write_b32 a50, v11
    v_accvgpr_write_b32 a51, v12
    v_accvgpr_read_b32 v11, a52
    v_accvgpr_read_b32 v12, a53
    v_mul_f32 v11, v11, v10
    v_mul_f32 v12, v12, v10
    v_accvgpr_write_b32 a52, v11
    v_accvgpr_write_b32 a53, v12
    v_accvgpr_read_b32 v11, a54
    v_accvgpr_read_b32 v12, a55
    v_mul_f32 v11, v11, v10
    v_mul_f32 v12, v12, v10
    v_accvgpr_write_b32 a54, v11
    v_accvgpr_write_b32 a55, v12
    v_accvgpr_read_b32 v11, a56
    v_accvgpr_read_b32 v12, a57
    v_mul_f32 v11, v11, v10
    v_mul_f32 v12, v12, v10
    v_accvgpr_write_b32 a56, v11
    v_accvgpr_write_b32 a57, v12
    v_accvgpr_read_b32 v11, a58
    v_accvgpr_read_b32 v12, a59
    v_mul_f32 v11, v11, v10
    v_mul_f32 v12, v12, v10
    v_accvgpr_write_b32 a58, v11
    v_accvgpr_write_b32 a59, v12
    v_accvgpr_read_b32 v11, a60
    v_accvgpr_read_b32 v12, a61
    v_mul_f32 v11, v11, v10
    v_mul_f32 v12, v12, v10
    v_accvgpr_write_b32 a60, v11
    v_accvgpr_write_b32 a61, v12
    v_accvgpr_read_b32 v11, a62
    v_accvgpr_read_b32 v12, a63
    v_mul_f32 v11, v11, v10
    v_mul_f32 v12, v12, v10
    v_accvgpr_write_b32 a62, v11
    v_accvgpr_write_b32 a63, v12
    v_mov_b32 v250, 0
    v_sub_f32 v11, v16, v8
    v_sub_f32 v12, v17, v8
    v_exp_f32 v11, v11
    v_exp_f32 v12, v12
    s_nop 0
    v_add_f32 v250, v250, v11
    v_add_f32 v250, v250, v12
    v_cvt_pk_bf16_f32 v176, v11, v12
    v_sub_f32 v11, v18, v8
    v_sub_f32 v12, v19, v8
    v_exp_f32 v11, v11
    v_exp_f32 v12, v12
    s_nop 0
    v_add_f32 v250, v250, v11
    v_add_f32 v250, v250, v12
    v_cvt_pk_bf16_f32 v177, v11, v12
    v_sub_f32 v11, v20, v8
    v_sub_f32 v12, v21, v8
    v_exp_f32 v11, v11
    v_exp_f32 v12, v12
    s_nop 0
    v_add_f32 v250, v250, v11
    v_add_f32 v250, v250, v12
    v_cvt_pk_bf16_f32 v178, v11, v12
    v_sub_f32 v11, v22, v8
    v_sub_f32 v12, v23, v8
    v_exp_f32 v11, v11
    v_exp_f32 v12, v12
    s_nop 0
    v_add_f32 v250, v250, v11
    v_add_f32 v250, v250, v12
    v_cvt_pk_bf16_f32 v179, v11, v12
    v_sub_f32 v11, v24, v8
    v_sub_f32 v12, v25, v8
    v_exp_f32 v11, v11
    v_exp_f32 v12, v12
    s_nop 0
    v_add_f32 v250, v250, v11
    v_add_f32 v250, v250, v12
    v_cvt_pk_bf16_f32 v180, v11, v12
    v_sub_f32 v11, v26, v8
    v_sub_f32 v12, v27, v8
    v_exp_f32 v11, v11
    v_exp_f32 v12, v12
    s_nop 0
    v_add_f32 v250, v250, v11
    v_add_f32 v250, v250, v12
    v_cvt_pk_bf16_f32 v181, v11, v12
    v_sub_f32 v11, v28, v8
    v_sub_f32 v12, v29, v8
    v_exp_f32 v11, v11
    v_exp_f32 v12, v12
    s_nop 0
    v_add_f32 v250, v250, v11
    v_add_f32 v250, v250, v12
    v_cvt_pk_bf16_f32 v182, v11, v12
    v_sub_f32 v11, v30, v8
    v_sub_f32 v12, v31, v8
    v_exp_f32 v11, v11
    v_exp_f32 v12, v12
    s_nop 0
    v_add_f32 v250, v250, v11
    v_add_f32 v250, v250, v12
    v_cvt_pk_bf16_f32 v183, v11, v12
    s_nop 1
    s_setpc_b64 s[54:55]
L_slow1:
    v_max3_f32 v8, v32, v33, v34
    v_max3_f32 v8, v8, v35, v36
    v_max3_f32 v8, v8, v37, v38
    v_max3_f32 v8, v8, v39, v40
    v_max3_f32 v8, v8, v41, v42
    v_max3_f32 v8, v8, v43, v44
    v_max3_f32 v8, v8, v45, v46
    v_max_f32 v8, v8, v47
    v_mov_b32 v9, v8
    s_nop 1
    v_permlane32_swap_b32 v8, v9
    v_max_f32 v8, v8, v9
    v_max_f32 v8, 0, v8
    v_sub_f32 v10, 0, v8
    v_exp_f32 v10, v10
    v_sub_f32 v80, v80, v8
    v_mov_b32 v81, v80
    v_mov_b32 v82, v80
    v_mov_b32 v83, v80
    v_mov_b32 v84, v80
    v_mov_b32 v85, v80
    v_mov_b32 v86, v80
    v_mov_b32 v87, v80
    v_mov_b32 v88, v80
    v_mov_b32 v89, v80
    v_mov_b32 v90, v80
    v_mov_b32 v91, v80
    v_mov_b32 v92, v80
    v_mov_b32 v93, v80
    v_mov_b32 v94, v80
    v_mov_b32 v95, v80
    v_mul_f32 v248, v248, v10
    v_accvgpr_read_b32 v11, a64
    v_accvgpr_read_b32 v12, a65
    v_mul_f32 v11, v11, v10
    v_mul_f32 v12, v12, v10
    v_accvgpr_write_b32 a64, v11
    v_accvgpr_write_b32 a65, v12
    v_accvgpr_read_b32 v11, a66
    v_accvgpr_read_b32 v12, a67
    v_mul_f32 v11, v11, v10
    v_mul_f32 v12, v12, v10
    v_accvgpr_write_b32 a66, v11
    v_accvgpr_write_b32 a67, v12
    v_accvgpr_read_b32 v11, a68
    v_accvgpr_read_b32 v12, a69
    v_mul_f32 v11, v11, v10
    v_mul_f32 v12, v12, v10
    v_accvgpr_write_b32 a68, v11
    v_accvgpr_write_b32 a69, v12
    v_accvgpr_read_b32 v11, a70
    v_accvgpr_read_b32 v12, a71
    v_mul_f32 v11, v11, v10
    v_mul_f32 v12, v12, v10
    v_accvgpr_write_b32 a70, v11
    v_accvgpr_write_b32 a71, v12
    v_accvgpr_read_b32 v11, a72
    v_accvgpr_read_b32 v12, a73
    v_mul_f32 v11, v11, v10
    v_mul_f32 v12, v12, v10
    v_accvgpr_write_b32 a72, v11
    v_accvgpr_write_b32 a73, v12
    v_accvgpr_read_b32 v11, a74
    v_accvgpr_read_b32 v12, a75
    v_mul_f32 v11, v11, v10
    v_mul_f32 v12, v12, v10
    v_accvgpr_write_b32 a74, v11
    v_accvgpr_write_b32 a75, v12
    v_accvgpr_read_b32 v11, a76
    v_accvgpr_read_b32 v12, a77
    v_mul_f32 v11, v11, v10
    v_mul_f32 v12, v12, v10
    v_accvgpr_write_b32 a76, v11
    v_accvgpr_write_b32 a77, v12
    v_accvgpr_read_b32 v11, a78
    v_accvgpr_read_b32 v12, a79
    v_mul_f32 v11, v11, v10
    v_mul_f32 v12, v12, v10
    v_accvgpr_write_b32 a78, v11
    v_accvgpr_write_b32 a79, v12
    v_accvgpr_read_b32 v11, a80
    v_accvgpr_read_b32 v12, a81
    v_mul_f32 v11, v11, v10
    v_mul_f32 v12, v12, v10
    v_accvgpr_write_b32 a80, v11
    v_accvgpr_write_b32 a81, v12
    v_accvgpr_read_b32 v11, a82
    v_accvgpr_read_b32 v12, a83
    v_mul_f32 v11, v11, v10
    v_mul_f32 v12, v12, v10
    v_accvgpr_write_b32 a82, v11
    v_accvgpr_write_b32 a83, v12
    v_accvgpr_read_b32 v11, a84
    v_accvgpr_read_b32 v12, a85
    v_mul_f32 v11, v11, v10
    v_mul_f32 v12, v12, v10
    v_accvgpr_write_b32 a84, v11
    v_accvgpr_write_b32 a85, v12
    v_accvgpr_read_b32 v11, a86
    v_accvgpr_read_b32 v12, a87
    v_mul_f32 v11, v11, v10
    v_mul_f32 v12, v12, v10
    v_accvgpr_write_b32 a86, v11
    v_accvgpr_write_b32 a87, v12
    v_accvgpr_read_b32 v11, a88
    v_accvgpr_read_b32 v12, a89
    v_mul_f32 v11, v11, v10
    v_mul_f32 v12, v12, v10
    v_accvgpr_write_b32 a88, v11
    v_accvgpr_write_b32 a89, v12
    v_accvgpr_read_b32 v11, a90
    v_accvgpr_read_b32 v12, a91
    v_mul_f32 v11, v11, v10
    v_mul_f32 v12, v12, v10
    v_accvgpr_write_b32 a90, v11
    v_accvgpr_write_b32 a91, v12
    v_accvgpr_read_b32 v11, a92
    v_accvgpr_read_b32 v12, a93
    v_mul_f32 v11, v11, v10
    v_mul_f32 v12, v12, v10
    v_accvgpr_write_b32 a92, v11
    v_accvgpr_write_b32 a93, v12
    v_accvgpr_read_b32 v11, a94
    v_accvgpr_read_b32 v12, a95
    v_mul_f32 v11, v11, v10
    v_mul_f32 v12, v12, v10
    v_accvgpr_write_b32 a94, v11
    v_accvgpr_write_b32 a95, v12
    v_accvgpr_read_b32 v11, a96
    v_accvgpr_read_b32 v12, a97
    v_mul_f32 v11, v11, v10
    v_mul_f32 v12, v12, v10
    v_accvgpr_write_b32 a96, v11
    v_accvgpr_write_b32 a97, v12
    v_accvgpr_read_b32 v11, a98
    v_accvgpr_read_b32 v12, a99
    v_mul_f32 v11, v11, v10
    v_mul_f32 v12, v12, v10
    v_accvgpr_write_b32 a98, v11
    v_accvgpr_write_b32 a99, v12
    v_accvgpr_read_b32 v11, a100
    v_accvgpr_read_b32 v12, a101
    v_mul_f32 v11, v11, v10
    v_mul_f32 v12, v12, v10
    v_accvgpr_write_b32 a100, v11
    v_accvgpr_write_b32 a101, v12
    v_accvgpr_read_b32 v11, a102
    v_accvgpr_read_b32 v12, a103
    v_mul_f32 v11, v11, v10
    v_mul_f32 v12, v12, v10
    v_accvgpr_write_b32 a102, v11
    v_accvgpr_write_b32 a103, v12
    v_accvgpr_read_b32 v11, a104
    v_accvgpr_read_b32 v12, a105
    v_mul_f32 v11, v11, v10
    v_mul_f32 v12, v12, v10
    v_accvgpr_write_b32 a104, v11
    v_accvgpr_write_b32 a105, v12
    v_accvgpr_read_b32 v11, a106
    v_accvgpr_read_b32 v12, a107
    v_mul_f32 v11, v11, v10
    v_mul_f32 v12, v12, v10
    v_accvgpr_write_b32 a106, v11
    v_accvgpr_write_b32 a107, v12
    v_accvgpr_read_b32 v11, a108
    v_accvgpr_read_b32 v12, a109
    v_mul_f32 v11, v11, v10
    v_mul_f32 v12, v12, v10
    v_accvgpr_write_b32 a108, v11
    v_accvgpr_write_b32 a109, v12
    v_accvgpr_read_b32 v11, a110
    v_accvgpr_read_b32 v12, a111
    v_mul_f32 v11, v11, v10
    v_mul_f32 v12, v12, v10
    v_accvgpr_write_b32 a110, v11
    v_accvgpr_write_b32 a111, v12
    v_accvgpr_read_b32 v11, a112
    v_accvgpr_read_b32 v12, a113
    v_mul_f32 v11, v11, v10
    v_mul_f32 v12, v12, v10
    v_accvgpr_write_b32 a112, v11
    v_accvgpr_write_b32 a113, v12
    v_accvgpr_read_b32 v11, a114
    v_accvgpr_read_b32 v12, a115
    v_mul_f32 v11, v11, v10
    v_mul_f32 v12, v12, v10
    v_accvgpr_write_b32 a114, v11
    v_accvgpr_write_b32 a115, v12
    v_accvgpr_read_b32 v11, a116
    v_accvgpr_read_b32 v12, a117
    v_mul_f32 v11, v11, v10
    v_mul_f32 v12, v12, v10
    v_accvgpr_write_b32 a116, v11
    v_accvgpr_write_b32 a117, v12
    v_accvgpr_read_b32 v11, a118
    v_accvgpr_read_b32 v12, a119
    v_mul_f32 v11, v11, v10
    v_mul_f32 v12, v12, v10
    v_accvgpr_write_b32 a118, v11
    v_accvgpr_write_b32 a119, v12
    v_accvgpr_read_b32 v11, a120
    v_accvgpr_read_b32 v12, a121
    v_mul_f32 v11, v11, v10
    v_mul_f32 v12, v12, v10
    v_accvgpr_write_b32 a120, v11
    v_accvgpr_write_b32 a121, v12
    v_accvgpr_read_b32 v11, a122
    v_accvgpr_read_b32 v12, a123
    v_mul_f32 v11, v11, v10
    v_mul_f32 v12, v12, v10
    v_accvgpr_write_b32 a122, v11
    v_accvgpr_write_b32 a123, v12
    v_accvgpr_read_b32 v11, a124
    v_accvgpr_read_b32 v12, a125
    v_mul_f32 v11, v11, v10
    v_mul_f32 v12, v12, v10
    v_accvgpr_write_b32 a124, v11
    v_accvgpr_write_b32 a125, v12
    v_accvgpr_read_b32 v11, a126
    v_accvgpr_read_b32 v12, a127
    v_mul_f32 v11, v11, v10
    v_mul_f32 v12, v12, v10
    v_accvgpr_write_b32 a126, v11
    v_accvgpr_write_b32 a127, v12
    v_mov_b32 v251, 0
    v_sub_f32 v11, v32, v8
    v_sub_f32 v12, v33, v8
    v_exp_f32 v11, v11
    v_exp_f32 v12, v12
    s_nop 0
    v_add_f32 v251, v251, v11
    v_add_f32 v251, v251, v12
    v_cvt_pk_bf16_f32 v184, v11, v12
    v_sub_f32 v11, v34, v8
    v_sub_f32 v12, v35, v8
    v_exp_f32 v11, v11
    v_exp_f32 v12, v12
    s_nop 0
    v_add_f32 v251, v251, v11
    v_add_f32 v251, v251, v12
    v_cvt_pk_bf16_f32 v185, v11, v12
    v_sub_f32 v11, v36, v8
    v_sub_f32 v12, v37, v8
    v_exp_f32 v11, v11
    v_exp_f32 v12, v12
    s_nop 0
    v_add_f32 v251, v251, v11
    v_add_f32 v251, v251, v12
    v_cvt_pk_bf16_f32 v186, v11, v12
    v_sub_f32 v11, v38, v8
    v_sub_f32 v12, v39, v8
    v_exp_f32 v11, v11
    v_exp_f32 v12, v12
    s_nop 0
    v_add_f32 v251, v251, v11
    v_add_f32 v251, v251, v12
    v_cvt_pk_bf16_f32 v187, v11, v12
    v_sub_f32 v11, v40, v8
    v_sub_f32 v12, v41, v8
    v_exp_f32 v11, v11
    v_exp_f32 v12, v12
    s_nop 0
    v_add_f32 v251, v251, v11
    v_add_f32 v251, v251, v12
    v_cvt_pk_bf16_f32 v188, v11, v12
    v_sub_f32 v11, v42, v8
    v_sub_f32 v12, v43, v8
    v_exp_f32 v11, v11
    v_exp_f32 v12, v12
    s_nop 0
    v_add_f32 v251, v251, v11
    v_add_f32 v251, v251, v12
    v_cvt_pk_bf16_f32 v189, v11, v12
    v_sub_f32 v11, v44, v8
    v_sub_f32 v12, v45, v8
    v_exp_f32 v11, v11
    v_exp_f32 v12, v12
    s_nop 0
    v_add_f32 v251, v251, v11
    v_add_f32 v251, v251, v12
    v_cvt_pk_bf16_f32 v190, v11, v12
    v_sub_f32 v11, v46, v8
    v_sub_f32 v12, v47, v8
    v_exp_f32 v11, v11
    v_exp_f32 v12, v12
    s_nop 0
    v_add_f32 v251, v251, v11
    v_add_f32 v251, v251, v12
    v_cvt_pk_bf16_f32 v191, v11, v12
    s_nop 1
    s_setpc_b64 s[54:55]
L_slow2:
    v_max3_f32 v8, v48, v49, v50
    v_max3_f32 v8, v8, v51, v52
    v_max3_f32 v8, v8, v53, v54
    v_max3_f32 v8, v8, v55, v56
    v_max3_f32 v8, v8, v57, v58
    v_max3_f32 v8, v8, v59, v60
    v_max3_f32 v8, v8, v61, v62
    v_max_f32 v8, v8, v63
    v_mov_b32 v9, v8
    s_nop 1
    v_permlane32_swap_b32 v8, v9
    v_max_f32 v8, v8, v9
    v_max_f32 v8, 0, v8
    v_sub_f32 v10, 0, v8
    v_exp_f32 v10, v10
    v_sub_f32 v96, v96, v8
    v_mov_b32 v97, v96
    v_mov_b32 v98, v96
    v_mov_b32 v99, v96
    v_mov_b32 v100, v96
    v_mov_b32 v101, v96
    v_mov_b32 v102, v96
    v_mov_b32 v103, v96
    v_mov_b32 v104, v96
    v_mov_b32 v105, v96
    v_mov_b32 v106, v96
    v_mov_b32 v107, v96
    v_mov_b32 v108, v96
    v_mov_b32 v109, v96
    v_mov_b32 v110, v96
    v_mov_b32 v111, v96
    v_mul_f32 v249, v249, v10
    v_accvgpr_read_b32 v11, a128
    v_accvgpr_read_b32 v12, a129
    v_mul_f32 v11, v11, v10
    v_mul_f32 v12, v12, v10
    v_accvgpr_write_b32 a128, v11
    v_accvgpr_write_b32 a129, v12
    v_accvgpr_read_b32 v11, a130
    v_accvgpr_read_b32 v12, a131
    v_mul_f32 v11, v11, v10
    v_mul_f32 v12, v12, v10
    v_accvgpr_write_b32 a130, v11
    v_accvgpr_write_b32 a131, v12
    v_accvgpr_read_b32 v11, a132
    v_accvgpr_read_b32 v12, a133
    v_mul_f32 v11, v11, v10
    v_mul_f32 v12, v12, v10
    v_accvgpr_write_b32 a132, v11
    v_accvgpr_write_b32 a133, v12
    v_accvgpr_read_b32 v11, a134
    v_accvgpr_read_b32 v12, a135
    v_mul_f32 v11, v11, v10
    v_mul_f32 v12, v12, v10
    v_accvgpr_write_b32 a134, v11
    v_accvgpr_write_b32 a135, v12
    v_accvgpr_read_b32 v11, a136
    v_accvgpr_read_b32 v12, a137
    v_mul_f32 v11, v11, v10
    v_mul_f32 v12, v12, v10
    v_accvgpr_write_b32 a136, v11
    v_accvgpr_write_b32 a137, v12
    v_accvgpr_read_b32 v11, a138
    v_accvgpr_read_b32 v12, a139
    v_mul_f32 v11, v11, v10
    v_mul_f32 v12, v12, v10
    v_accvgpr_write_b32 a138, v11
    v_accvgpr_write_b32 a139, v12
    v_accvgpr_read_b32 v11, a140
    v_accvgpr_read_b32 v12, a141
    v_mul_f32 v11, v11, v10
    v_mul_f32 v12, v12, v10
    v_accvgpr_write_b32 a140, v11
    v_accvgpr_write_b32 a141, v12
    v_accvgpr_read_b32 v11, a142
    v_accvgpr_read_b32 v12, a143
    v_mul_f32 v11, v11, v10
    v_mul_f32 v12, v12, v10
    v_accvgpr_write_b32 a142, v11
    v_accvgpr_write_b32 a143, v12
    v_accvgpr_read_b32 v11, a144
    v_accvgpr_read_b32 v12, a145
    v_mul_f32 v11, v11, v10
    v_mul_f32 v12, v12, v10
    v_accvgpr_write_b32 a144, v11
    v_accvgpr_write_b32 a145, v12
    v_accvgpr_read_b32 v11, a146
    v_accvgpr_read_b32 v12, a147
    v_mul_f32 v11, v11, v10
    v_mul_f32 v12, v12, v10
    v_accvgpr_write_b32 a146, v11
    v_accvgpr_write_b32 a147, v12
    v_accvgpr_read_b32 v11, a148
    v_accvgpr_read_b32 v12, a149
    v_mul_f32 v11, v11, v10
    v_mul_f32 v12, v12, v10
    v_accvgpr_write_b32 a148, v11
    v_accvgpr_write_b32 a149, v12
    v_accvgpr_read_b32 v11, a150
    v_accvgpr_read_b32 v12, a151
    v_mul_f32 v11, v11, v10
    v_mul_f32 v12, v12, v10
    v_accvgpr_write_b32 a150, v11
    v_accvgpr_write_b32 a151, v12
    v_accvgpr_read_b32 v11, a152
    v_accvgpr_read_b32 v12, a153
    v_mul_f32 v11, v11, v10
    v_mul_f32 v12, v12, v10
    v_accvgpr_write_b32 a152, v11
    v_accvgpr_write_b32 a153, v12
    v_accvgpr_read_b32 v11, a154
    v_accvgpr_read_b32 v12, a155
    v_mul_f32 v11, v11, v10
    v_mul_f32 v12, v12, v10
    v_accvgpr_write_b32 a154, v11
    v_accvgpr_write_b32 a155, v12
    v_accvgpr_read_b32 v11, a156
    v_accvgpr_read_b32 v12, a157
    v_mul_f32 v11, v11, v10
    v_mul_f32 v12, v12, v10
    v_accvgpr_write_b32 a156, v11
    v_accvgpr_write_b32 a157, v12
    v_accvgpr_read_b32 v11, a158
    v_accvgpr_read_b32 v12, a159
    v_mul_f32 v11, v11, v10
    v_mul_f32 v12, v12, v10
    v_accvgpr_write_b32 a158, v11
    v_accvgpr_write_b32 a159, v12
    v_accvgpr_read_b32 v11, a160
    v_accvgpr_read_b32 v12, a161
    v_mul_f32 v11, v11, v10
    v_mul_f32 v12, v12, v10
    v_accvgpr_write_b32 a160, v11
    v_accvgpr_write_b32 a161, v12
    v_accvgpr_read_b32 v11, a162
    v_accvgpr_read_b32 v12, a163
    v_mul_f32 v11, v11, v10
    v_mul_f32 v12, v12, v10
    v_accvgpr_write_b32 a162, v11
    v_accvgpr_write_b32 a163, v12
    v_accvgpr_read_b32 v11, a164
    v_accvgpr_read_b32 v12, a165
    v_mul_f32 v11, v11, v10
    v_mul_f32 v12, v12, v10
    v_accvgpr_write_b32 a164, v11
    v_accvgpr_write_b32 a165, v12
    v_accvgpr_read_b32 v11, a166
    v_accvgpr_read_b32 v12, a167
    v_mul_f32 v11, v11, v10
    v_mul_f32 v12, v12, v10
    v_accvgpr_write_b32 a166, v11
    v_accvgpr_write_b32 a167, v12
    v_accvgpr_read_b32 v11, a168
    v_accvgpr_read_b32 v12, a169
    v_mul_f32 v11, v11, v10
    v_mul_f32 v12, v12, v10
    v_accvgpr_write_b32 a168, v11
    v_accvgpr_write_b32 a169, v12
    v_accvgpr_read_b32 v11, a170
    v_accvgpr_read_b32 v12, a171
    v_mul_f32 v11, v11, v10
    v_mul_f32 v12, v12, v10
    v_accvgpr_write_b32 a170, v11
    v_accvgpr_write_b32 a171, v12
    v_accvgpr_read_b32 v11, a172
    v_accvgpr_read_b32 v12, a173
    v_mul_f32 v11, v11, v10
    v_mul_f32 v12, v12, v10
    v_accvgpr_write_b32 a172, v11
    v_accvgpr_write_b32 a173, v12
    v_accvgpr_read_b32 v11, a174
    v_accvgpr_read_b32 v12, a175
    v_mul_f32 v11, v11, v10
    v_mul_f32 v12, v12, v10
    v_accvgpr_write_b32 a174, v11
    v_accvgpr_write_b32 a175, v12
    v_accvgpr_read_b32 v11, a176
    v_accvgpr_read_b32 v12, a177
    v_mul_f32 v11, v11, v10
    v_mul_f32 v12, v12, v10
    v_accvgpr_write_b32 a176, v11
    v_accvgpr_write_b32 a177, v12
    v_accvgpr_read_b32 v11, a178
    v_accvgpr_read_b32 v12, a179
    v_mul_f32 v11, v11, v10
    v_mul_f32 v12, v12, v10
    v_accvgpr_write_b32 a178, v11
    v_accvgpr_write_b32 a179, v12
    v_accvgpr_read_b32 v11, a180
    v_accvgpr_read_b32 v12, a181
    v_mul_f32 v11, v11, v10
    v_mul_f32 v12, v12, v10
    v_accvgpr_write_b32 a180, v11
    v_accvgpr_write_b32 a181, v12
    v_accvgpr_read_b32 v11, a182
    v_accvgpr_read_b32 v12, a183
    v_mul_f32 v11, v11, v10
    v_mul_f32 v12, v12, v10
    v_accvgpr_write_b32 a182, v11
    v_accvgpr_write_b32 a183, v12
    v_accvgpr_read_b32 v11, a184
    v_accvgpr_read_b32 v12, a185
    v_mul_f32 v11, v11, v10
    v_mul_f32 v12, v12, v10
    v_accvgpr_write_b32 a184, v11
    v_accvgpr_write_b32 a185, v12
    v_accvgpr_read_b32 v11, a186
    v_accvgpr_read_b32 v12, a187
    v_mul_f32 v11, v11, v10
    v_mul_f32 v12, v12, v10
    v_accvgpr_write_b32 a186, v11
    v_accvgpr_write_b32 a187, v12
    v_accvgpr_read_b32 v11, a188
    v_accvgpr_read_b32 v12, a189
    v_mul_f32 v11, v11, v10
    v_mul_f32 v12, v12, v10
    v_accvgpr_write_b32 a188, v11
    v_accvgpr_write_b32 a189, v12
    v_accvgpr_read_b32 v11, a190
    v_accvgpr_read_b32 v12, a191
    v_mul_f32 v11, v11, v10
    v_mul_f32 v12, v12, v10
    v_accvgpr_write_b32 a190, v11
    v_accvgpr_write_b32 a191, v12
    v_mov_b32 v252, 0
    v_sub_f32 v11, v48, v8
    v_sub_f32 v12, v49, v8
    v_exp_f32 v11, v11
    v_exp_f32 v12, v12
    s_nop 0
    v_add_f32 v252, v252, v11
    v_add_f32 v252, v252, v12
    v_cvt_pk_bf16_f32 v192, v11, v12
    v_sub_f32 v11, v50, v8
    v_sub_f32 v12, v51, v8
    v_exp_f32 v11, v11
    v_exp_f32 v12, v12
    s_nop 0
    v_add_f32 v252, v252, v11
    v_add_f32 v252, v252, v12
    v_cvt_pk_bf16_f32 v193, v11, v12
    v_sub_f32 v11, v52, v8
    v_sub_f32 v12, v53, v8
    v_exp_f32 v11, v11
    v_exp_f32 v12, v12
    s_nop 0
    v_add_f32 v252, v252, v11
    v_add_f32 v252, v252, v12
    v_cvt_pk_bf16_f32 v194, v11, v12
    v_sub_f32 v11, v54, v8
    v_sub_f32 v12, v55, v8
    v_exp_f32 v11, v11
    v_exp_f32 v12, v12
    s_nop 0
    v_add_f32 v252, v252, v11
    v_add_f32 v252, v252, v12
    v_cvt_pk_bf16_f32 v195, v11, v12
    v_sub_f32 v11, v56, v8
    v_sub_f32 v12, v57, v8
    v_exp_f32 v11, v11
    v_exp_f32 v12, v12
    s_nop 0
    v_add_f32 v252, v252, v11
    v_add_f32 v252, v252, v12
    v_cvt_pk_bf16_f32 v196, v11, v12
    v_sub_f32 v11, v58, v8
    v_sub_f32 v12, v59, v8
    v_exp_f32 v11, v11
    v_exp_f32 v12, v12
    s_nop 0
    v_add_f32 v252, v252, v11
    v_add_f32 v252, v252, v12
    v_cvt_pk_bf16_f32 v197, v11, v12
    v_sub_f32 v11, v60, v8
    v_sub_f32 v12, v61, v8
    v_exp_f32 v11, v11
    v_exp_f32 v12, v12
    s_nop 0
    v_add_f32 v252, v252, v11
    v_add_f32 v252, v252, v12
    v_cvt_pk_bf16_f32 v198, v11, v12
    v_sub_f32 v11, v62, v8
    v_sub_f32 v12, v63, v8
    v_exp_f32 v11, v11
    v_exp_f32 v12, v12
    s_nop 0
    v_add_f32 v252, v252, v11
    v_add_f32 v252, v252, v12
    v_cvt_pk_bf16_f32 v199, v11, v12
    s_nop 1
    s_setpc_b64 s[54:55]
L_codeend:

.section .rodata,"a"
.p2align 6
.amdhsa_kernel concat_heads__gqa_block_cached__gqa_block_cached__near_ridge_kernel
  .amdhsa_next_free_vgpr 512
  .amdhsa_next_free_sgpr 102
  .amdhsa_accum_offset 256
  .amdhsa_group_segment_fixed_size 0
  .amdhsa_kernarg_size 104
  .amdhsa_user_sgpr_count 2
  .amdhsa_user_sgpr_kernarg_segment_ptr 1
  .amdhsa_system_sgpr_workgroup_id_x 1
.end_amdhsa_kernel
```
